```python
import torch

def _softmax(x, axis=-1):
    return torch.softmax(x, dim=axis)
def _gelu(x):
    return torch.nn.functional.gelu(x, approximate="tanh")
def _silu(x):
    return torch.nn.functional.silu(x)
def _sigmoid(x):
    return torch.sigmoid(x)
def _layernorm(x, axis=-1, eps=1e-5):
    m = x.mean(dim=axis, keepdim=True)
    v = x.var(dim=axis, keepdim=True, unbiased=False)
    return (x - m) / torch.sqrt(v + eps)
def _scatter_add(tgt, idx, src, axis=0):
    return tgt.clone().index_add_(axis, idx, src)
def _segment_sum(src, seg, n):
    out = torch.zeros((n,) + src.shape[1:], dtype=src.dtype)
    return out.index_add_(0, seg, src)
def _pad(x, pw):
    flat = tuple(v for pair in reversed(pw) for v in pair)
    return torch.nn.functional.pad(x, flat)

kernel_name = 'standalone__mha_block_cached__near_ridge'

def setup_inputs():

    _w = (lambda a: (lambda t: t.to(torch.bfloat16) if t.is_floating_point() else t)(torch.as_tensor(a)))
    B, Sq, D = 32, 32, 448
    H, Sk, Dh = 16, 32, 256
    return {
        "x": _w((lambda *s: torch.randn(*s, dtype=torch.bfloat16) * 0.8)(B, Sq, D)),
        "k_cache": _w((lambda *s: torch.randn(*s, dtype=torch.bfloat16) * 0.8)(B, H, Sk, Dh)),
        "v_cache": _w((lambda *s: torch.randn(*s, dtype=torch.bfloat16) * 0.05)(B, H, Sk, Dh)),
        "wq": _w((lambda *s: torch.randn(*s, dtype=torch.bfloat16) * 0.8)(D, H * Dh) * (D ** -0.5)),
        "wo": _w((lambda *s: torch.randn(*s, dtype=torch.bfloat16) * 0.05)(H * Dh, D) * ((H * Dh) ** -0.5)),
    }

def reference(x, k_cache, v_cache, wq, wo):
    B, Sq, D = x.shape
    H, Dh = 16, 256
    q = (lambda x, *d: x.permute(*d))((x @ wq).reshape(B, Sq, H, Dh), 0, 2, 1, 3)
    scores = torch.einsum("bhqd,bhkd->bhqk", q, k_cache) * (Dh ** -0.5)
    p = _softmax(scores, axis=-1)
    o = torch.einsum("bhqk,bhkd->bhqd", p, v_cache)
    return (lambda x, *d: x.permute(*d))(o, 0, 2, 1, 3).reshape(B, Sq, H * Dh) @ wo
```

```asm
; @launch grid=(256,1,1) block=(512,1,1) lds=163840
.amdgcn_target "amdgcn-amd-amdhsa--gfx950"
.text
.globl standalone__mha_block_cached__near_ridge_kernel
.p2align 8
.type standalone__mha_block_cached__near_ridge_kernel,@function
standalone__mha_block_cached__near_ridge_kernel:
L_begin:
    s_load_dwordx16 s[4:19], s[0:1], 0
    s_cmp_ge_u32 s2, 256
    s_cbranch_scc1 L_end
    v_lshrrev_b32 v2, 6, v0
    v_and_b32 v1, 63, v0
    s_lshr_b32 s22, s2, 3
    v_readfirstlane_b32 s20, v2
    s_xor_b32 s22, s22, 16
    s_nop 0
    s_and_b32 s26, s20, 3
    s_lshl_b32 s60, s26, 12
    s_cmp_ge_u32 s20, 4
    s_cbranch_scc1 L_load
    v_lshl_add_u32 v250, v1, 5, s22
    v_lshlrev_b32 v250, 7, v250
    s_cmp_lg_u32 s26, 0
    s_cbranch_scc1 L_pfskip
    s_getpc_b64 s[58:59]
L_pc:
    s_sub_u32 s58, s58, L_pc-L_begin
    s_subb_u32 s59, s59, 0
    s_mov_b32 s57, L_end-L_begin
    v_cmp_gt_u32 vcc, s57, v250
    s_and_saveexec_b64 s[68:69], vcc
    global_load_dword v251, v250, s[58:59]
    s_mov_b64 exec, s[68:69]
L_pfskip:
    s_cmp_lt_u32 s22, 16
    s_cbranch_scc1 L_Ucomp
    s_branch L_Scomp
L_load:
    v_lshrrev_b32 v3, 4, v1
    v_and_b32 v14, 7, v1
    v_xor_b32 v14, v14, v3
    v_lshlrev_b32 v14, 4, v14
    v_lshrrev_b32 v13, 3, v1
    s_cmp_lt_u32 s22, 16
    s_cbranch_scc1 L_Uload
L_Sinit:
    v_mul_u32_u24 v12, 896, v13
    v_add_u32 v6, v12, v14
    v_xor_b32 v15, 64, v14
    v_add_u32 v7, v12, v15
    v_lshrrev_b32 v2, 5, v1
    v_and_b32 v12, 31, v1
    v_lshlrev_b32 v12, 4, v12
    s_and_b32 s56, s26, 1
    s_lshl_b32 s56, s56, 7
    v_lshlrev_b32 v11, 5, v2
    v_xor_b32 v4, v12, v11
    v_xor_b32 v4, s56, v4
    v_lshl_add_u32 v4, v2, 13, v4
    v_xor_b32 v5, 64, v4
    s_and_b32 s56, s2, 7
    s_and_b32 s57, s22, 1
    s_lshl_b32 s27, s56, 1
    s_add_u32 s27, s27, s57
    s_bfe_u32 s24, s22, 0x30001
    s_lshl_b32 s63, s26, 16
    s_lshl_b32 s57, s27, 9
    s_add_u32 s63, s63, s57
    s_lshl_b32 s57, s24, 2
    s_add_u32 s57, s57, s26
    s_mul_i32 s64, s57, 28672
    s_waitcnt lgkmcnt(0)
    s_mov_b32 s32, s4
    s_and_b32 s33, s5, 0xffff
    s_mov_b32 s34, 917504
    s_mov_b32 s35, 0x20000
    s_add_u32 m0, s60, 98304
    s_nop 0
    buffer_load_dwordx4 v6, s[32:35], s64 offen lds
    s_add_u32 s56, s64, 6144
    buffer_load_dwordx4 v7, s[32:35], s56 offen offset:1024 lds
    s_add_u32 s56, s64, 12288
    buffer_load_dwordx4 v6, s[32:35], s56 offen offset:2048 lds
    s_add_u32 s56, s64, 18432
    buffer_load_dwordx4 v7, s[32:35], s56 offen offset:3072 lds
    s_mov_b32 s36, s10
    s_and_b32 s37, s11, 0xffff
    s_mov_b32 s38, 3670016
    s_mov_b32 s39, 0x20000
    s_mov_b32 m0, s60
    s_nop 0
    buffer_load_dwordx4 v4, s[36:39], s63 offen lds
    s_add_u32 s56, s63, 15360
    buffer_load_dwordx4 v5, s[36:39], s56 offen offset:1024 lds
    s_add_u32 s56, s63, 30720
    buffer_load_dwordx4 v4, s[36:39], s56 offen offset:2048 lds
    s_add_u32 s56, s63, 46080
    buffer_load_dwordx4 v5, s[36:39], s56 offen offset:3072 lds
    s_add_u32 m0, s60, 16384
    s_add_u32 s56, s63, 262144
    buffer_load_dwordx4 v4, s[36:39], s56 offen lds
    s_add_u32 s56, s63, 277504
    buffer_load_dwordx4 v5, s[36:39], s56 offen offset:1024 lds
    s_add_u32 s56, s63, 292864
    buffer_load_dwordx4 v4, s[36:39], s56 offen offset:2048 lds
    s_add_u32 s56, s63, 308224
    buffer_load_dwordx4 v5, s[36:39], s56 offen offset:3072 lds
    s_branch L_Srest
L_Uload:
    s_and_b32 s23, s2, 3
    s_and_b32 s24, s2, 4
    s_bfe_u32 s56, s2, 0x20005
    s_add_u32 s24, s24, s56
    s_and_b32 s25, s22, 3
    s_add_u32 s29, s56, s25
    s_and_b32 s29, s29, 3
    v_lshl_add_u32 v4, v13, 9, v14
    v_xor_b32 v5, 64, v4
    s_lshl_b32 s56, s24, 2
    s_add_u32 s56, s56, s26
    s_lshl_b32 s56, s56, 2
    s_add_u32 s56, s56, s23
    s_lshl_b32 s63, s56, 16
    s_lshl_b32 s57, s23, 6
    s_add_u32 s57, s57, s26
    s_mul_i32 s64, s57, 14336
    s_lshl_b32 s57, s25, 8
    s_min_u32 s57, s57, 640
    s_add_u32 s64, s64, s57
    s_lshl_b32 s57, s29, 2
    s_bfe_u32 s59, s2, 0x20000
    s_lshl_b32 s59, s59, 1
    s_lshr_b32 s59, 64, s59
    s_and_b32 s59, s59, 3
    s_mov_b32 s58, s29
    s_cmp_eq_u32 s59, 1
    s_cselect_b32 s57, s58, s57
    s_lshr_b32 s65, s57, 2
    s_mul_i32 s65, s65, 15872
    s_lshl_b32 s67, s57, 7
    s_add_u32 s65, s65, s67
    s_add_u32 s65, s65, s63
    s_mul_i32 s66, s57, 57344
    s_add_u32 s66, s66, s64
    s_waitcnt lgkmcnt(0)
    s_mov_b32 s32, s8
    s_and_b32 s33, s9, 0xffff
    s_mov_b32 s34, 8388608
    s_mov_b32 s35, 0x20000
    s_mov_b32 m0, s60
    s_nop 0
    buffer_load_dwordx4 v4, s[32:35], s65 offen lds
    s_add_u32 s56, s65, 3072
    buffer_load_dwordx4 v5, s[32:35], s56 offen offset:1024 lds
    s_add_u32 s56, s65, 6144
    buffer_load_dwordx4 v4, s[32:35], s56 offen offset:2048 lds
    s_add_u32 s56, s65, 9216
    buffer_load_dwordx4 v5, s[32:35], s56 offen offset:3072 lds
    v_and_b32 v48, 15, v1
    v_lshlrev_b32 v48, 4, v48
    v_lshlrev_b32 v49, 5, v3
    v_xor_b32 v48, v48, v49
    v_mul_u32_u24 v49, 896, v3
    v_add_u32 v6, v48, v49
    v_xor_b32 v50, 0x80, v48
    v_add_u32 v2, v50, v49
    s_cmp_eq_u32 s25, 3
    s_cselect_b32 s56, 0x800000, 0
    v_and_b32 v48, 0x80, v48
    v_and_b32 v50, 0x80, v50
    v_mul_u32_u24 v48, s56, v48
    v_mul_u32_u24 v50, s56, v50
    s_mov_b32 s36, s12
    s_and_b32 s37, s13, 0xffff
    s_mov_b32 s38, 3670016
    s_mov_b32 s39, 0x20000
    v_add_u32 v6, v6, v50
    v_add_u32 v2, v2, v48
    s_add_u32 m0, s60, 16384
    s_nop 0
    buffer_load_dwordx4 v6, s[36:39], s66 offen lds
    s_add_u32 s56, s66, 2560
    buffer_load_dwordx4 v6, s[36:39], s56 offen offset:1024 lds
    s_add_u32 s56, s66, 5120
    buffer_load_dwordx4 v2, s[36:39], s56 offen offset:2048 lds
    s_add_u32 s56, s66, 7680
    buffer_load_dwordx4 v2, s[36:39], s56 offen offset:3072 lds
    v_mov_b32 v7, 0
    v_lshlrev_b32 v9, 4, v1
    v_add_u32 v11, s60, v9
    s_mov_b32 s44, s18
    s_and_b32 s45, s19, 0xffff
    s_mov_b32 s46, 268435456
    s_mov_b32 s47, 0x20000
    s_mov_b32 s48, s16
    s_and_b32 s49, s17, 0xffff
    s_mov_b32 s50, 256
    s_mov_b32 s51, 0x20000
    s_mov_b32 s52, s14
    s_and_b32 s53, s15, 0xffff
    s_mov_b32 s54, 917504
    s_mov_b32 s55, 0x20000
    s_lshl_b32 s14, s59, 2
    s_add_u32 s14, s14, s29
    s_mov_b32 s70, 0x76543210
    s_mov_b32 s71, 0xfedcba98
    s_mov_b32 s15, 0xe4
    s_cmp_eq_u32 s14, 1
    s_cmov_b32 s70, 0xba987654
    s_cmov_b32 s71, 0x3210fedc
    s_cmov_b32 s15, 0x93
    s_cmp_eq_u32 s14, 2
    s_cmov_b32 s70, 0xfedcba98
    s_cmov_b32 s71, 0x76543210
    s_cmov_b32 s15, 0x4e
    s_cmp_eq_u32 s14, 3
    s_cmov_b32 s70, 0x3210fedc
    s_cmov_b32 s71, 0xba987654
    s_cmov_b32 s15, 0x39
    s_cmp_eq_u32 s14, 4
    s_cmov_b32 s70, 0x76543210
    s_cmov_b32 s71, 0xfedcba98
    s_cmov_b32 s15, 0xe4
    s_cmp_eq_u32 s14, 5
    s_cmov_b32 s70, 0x47650321
    s_cmov_b32 s71, 0xfedc98ba
    s_cmov_b32 s15, 0xe4
    s_cmp_eq_u32 s14, 6
    s_cmov_b32 s70, 0x54761032
    s_cmov_b32 s71, 0xba98fedc
    s_cmov_b32 s15, 0xb4
    s_cmp_eq_u32 s14, 7
    s_cmov_b32 s70, 0x65472103
    s_cmov_b32 s71, 0xba98dcfe
    s_cmov_b32 s15, 0xb4
    s_bfe_u32 s57, s70, 0x40004
    s_lshr_b32 s65, s57, 2
    s_mul_i32 s65, s65, 15872
    s_lshl_b32 s67, s57, 7
    s_add_u32 s65, s65, s67
    s_add_u32 s65, s65, s63
    s_mul_i32 s66, s57, 57344
    s_add_u32 s66, s66, s64
    s_add_u32 m0, s60, 32768
    s_nop 0
    buffer_load_dwordx4 v4, s[32:35], s65 offen lds
    s_add_u32 s56, s65, 3072
    buffer_load_dwordx4 v5, s[32:35], s56 offen offset:1024 lds
    s_add_u32 s56, s65, 6144
    buffer_load_dwordx4 v4, s[32:35], s56 offen offset:2048 lds
    s_add_u32 s56, s65, 9216
    buffer_load_dwordx4 v5, s[32:35], s56 offen offset:3072 lds
    s_add_u32 m0, s60, 49152
    s_nop 0
    buffer_load_dwordx4 v6, s[36:39], s66 offen lds
    s_add_u32 s56, s66, 2560
    buffer_load_dwordx4 v6, s[36:39], s56 offen offset:1024 lds
    s_add_u32 s56, s66, 5120
    buffer_load_dwordx4 v2, s[36:39], s56 offen offset:2048 lds
    s_add_u32 s56, s66, 7680
    buffer_load_dwordx4 v2, s[36:39], s56 offen offset:3072 lds
    s_waitcnt vmcnt(8)
    s_barrier
    s_bfe_u32 s57, s70, 0x40008
    s_lshr_b32 s65, s57, 2
    s_mul_i32 s65, s65, 15872
    s_lshl_b32 s67, s57, 7
    s_add_u32 s65, s65, s67
    s_add_u32 s65, s65, s63
    s_mul_i32 s66, s57, 57344
    s_add_u32 s66, s66, s64
    s_add_u32 m0, s60, 65536
    s_nop 0
    buffer_load_dwordx4 v4, s[32:35], s65 offen lds
    s_add_u32 s56, s65, 3072
    buffer_load_dwordx4 v5, s[32:35], s56 offen offset:1024 lds
    s_add_u32 s56, s65, 6144
    buffer_load_dwordx4 v4, s[32:35], s56 offen offset:2048 lds
    s_add_u32 s56, s65, 9216
    buffer_load_dwordx4 v5, s[32:35], s56 offen offset:3072 lds
    s_add_u32 m0, s60, 81920
    s_nop 0
    buffer_load_dwordx4 v6, s[36:39], s66 offen lds
    s_add_u32 s56, s66, 2560
    buffer_load_dwordx4 v6, s[36:39], s56 offen offset:1024 lds
    s_add_u32 s56, s66, 5120
    buffer_load_dwordx4 v2, s[36:39], s56 offen offset:2048 lds
    s_add_u32 s56, s66, 7680
    buffer_load_dwordx4 v2, s[36:39], s56 offen offset:3072 lds
    s_waitcnt vmcnt(8)
    s_barrier
    s_bfe_u32 s57, s70, 0x4000c
    s_lshr_b32 s65, s57, 2
    s_mul_i32 s65, s65, 15872
    s_lshl_b32 s67, s57, 7
    s_add_u32 s65, s65, s67
    s_add_u32 s65, s65, s63
    s_mul_i32 s66, s57, 57344
    s_add_u32 s66, s66, s64
    s_add_u32 m0, s60, 98304
    s_nop 0
    buffer_load_dwordx4 v4, s[32:35], s65 offen lds
    s_add_u32 s56, s65, 3072
    buffer_load_dwordx4 v5, s[32:35], s56 offen offset:1024 lds
    s_add_u32 s56, s65, 6144
    buffer_load_dwordx4 v4, s[32:35], s56 offen offset:2048 lds
    s_add_u32 s56, s65, 9216
    buffer_load_dwordx4 v5, s[32:35], s56 offen offset:3072 lds
    s_add_u32 m0, s60, 114688
    s_nop 0
    buffer_load_dwordx4 v6, s[36:39], s66 offen lds
    s_add_u32 s56, s66, 2560
    buffer_load_dwordx4 v6, s[36:39], s56 offen offset:1024 lds
    s_add_u32 s56, s66, 5120
    buffer_load_dwordx4 v2, s[36:39], s56 offen offset:2048 lds
    s_add_u32 s56, s66, 7680
    buffer_load_dwordx4 v2, s[36:39], s56 offen offset:3072 lds
    buffer_load_dword v8, v7, s[48:51], 0 offen sc1
    s_waitcnt vmcnt(9)
    s_barrier
    s_bfe_u32 s57, s70, 0x40010
    s_lshr_b32 s65, s57, 2
    s_mul_i32 s65, s65, 15872
    s_lshl_b32 s67, s57, 7
    s_add_u32 s65, s65, s67
    s_add_u32 s65, s65, s63
    s_mul_i32 s66, s57, 57344
    s_add_u32 s66, s66, s64
    s_add_u32 m0, s60, 131072
    s_nop 0
    buffer_load_dwordx4 v4, s[32:35], s65 offen lds
    s_add_u32 s56, s65, 3072
    buffer_load_dwordx4 v5, s[32:35], s56 offen offset:1024 lds
    s_add_u32 s56, s65, 6144
    buffer_load_dwordx4 v4, s[32:35], s56 offen offset:2048 lds
    s_add_u32 s56, s65, 9216
    buffer_load_dwordx4 v5, s[32:35], s56 offen offset:3072 lds
    s_add_u32 m0, s60, 147456
    s_nop 0
    buffer_load_dwordx4 v6, s[36:39], s66 offen lds
    s_add_u32 s56, s66, 2560
    buffer_load_dwordx4 v6, s[36:39], s56 offen offset:1024 lds
    s_add_u32 s56, s66, 5120
    buffer_load_dwordx4 v2, s[36:39], s56 offen offset:2048 lds
    s_add_u32 s56, s66, 7680
    buffer_load_dwordx4 v2, s[36:39], s56 offen offset:3072 lds
    s_waitcnt vmcnt(9)
    s_barrier
    s_bfe_u32 s57, s70, 0x40014
    s_lshr_b32 s65, s57, 2
    s_mul_i32 s65, s65, 15872
    s_lshl_b32 s67, s57, 7
    s_add_u32 s65, s65, s67
    s_add_u32 s65, s65, s63
    s_mul_i32 s66, s57, 57344
    s_add_u32 s66, s66, s64
    s_mov_b32 m0, s60
    s_nop 0
    buffer_load_dwordx4 v4, s[32:35], s65 offen lds
    s_add_u32 s56, s65, 3072
    buffer_load_dwordx4 v5, s[32:35], s56 offen offset:1024 lds
    s_add_u32 s56, s65, 6144
    buffer_load_dwordx4 v4, s[32:35], s56 offen offset:2048 lds
    s_add_u32 s56, s65, 9216
    buffer_load_dwordx4 v5, s[32:35], s56 offen offset:3072 lds
    s_add_u32 m0, s60, 16384
    s_nop 0
    buffer_load_dwordx4 v6, s[36:39], s66 offen lds
    s_add_u32 s56, s66, 2560
    buffer_load_dwordx4 v6, s[36:39], s56 offen offset:1024 lds
    s_add_u32 s56, s66, 5120
    buffer_load_dwordx4 v2, s[36:39], s56 offen offset:2048 lds
    s_add_u32 s56, s66, 7680
    buffer_load_dwordx4 v2, s[36:39], s56 offen offset:3072 lds
    s_waitcnt vmcnt(8)
    s_barrier
    s_bfe_u32 s57, s70, 0x40018
    s_lshr_b32 s65, s57, 2
    s_mul_i32 s65, s65, 15872
    s_lshl_b32 s67, s57, 7
    s_add_u32 s65, s65, s67
    s_add_u32 s65, s65, s63
    s_mul_i32 s66, s57, 57344
    s_add_u32 s66, s66, s64
    s_add_u32 m0, s60, 32768
    s_nop 0
    buffer_load_dwordx4 v4, s[32:35], s65 offen lds
    s_add_u32 s56, s65, 3072
    buffer_load_dwordx4 v5, s[32:35], s56 offen offset:1024 lds
    s_add_u32 s56, s65, 6144
    buffer_load_dwordx4 v4, s[32:35], s56 offen offset:2048 lds
    s_add_u32 s56, s65, 9216
    buffer_load_dwordx4 v5, s[32:35], s56 offen offset:3072 lds
    s_add_u32 m0, s60, 49152
    s_nop 0
    buffer_load_dwordx4 v6, s[36:39], s66 offen lds
    s_add_u32 s56, s66, 2560
    buffer_load_dwordx4 v6, s[36:39], s56 offen offset:1024 lds
    s_add_u32 s56, s66, 5120
    buffer_load_dwordx4 v2, s[36:39], s56 offen offset:2048 lds
    s_add_u32 s56, s66, 7680
    buffer_load_dwordx4 v2, s[36:39], s56 offen offset:3072 lds
    s_waitcnt vmcnt(8)
    s_barrier
    s_bfe_u32 s57, s70, 0x4001c
    s_lshr_b32 s65, s57, 2
    s_mul_i32 s65, s65, 15872
    s_lshl_b32 s67, s57, 7
    s_add_u32 s65, s65, s67
    s_add_u32 s65, s65, s63
    s_mul_i32 s66, s57, 57344
    s_add_u32 s66, s66, s64
    s_add_u32 m0, s60, 65536
    s_nop 0
    buffer_load_dwordx4 v4, s[32:35], s65 offen lds
    s_add_u32 s56, s65, 3072
    buffer_load_dwordx4 v5, s[32:35], s56 offen offset:1024 lds
    s_add_u32 s56, s65, 6144
    buffer_load_dwordx4 v4, s[32:35], s56 offen offset:2048 lds
    s_add_u32 s56, s65, 9216
    buffer_load_dwordx4 v5, s[32:35], s56 offen offset:3072 lds
    s_add_u32 m0, s60, 81920
    s_nop 0
    buffer_load_dwordx4 v6, s[36:39], s66 offen lds
    s_add_u32 s56, s66, 2560
    buffer_load_dwordx4 v6, s[36:39], s56 offen offset:1024 lds
    s_add_u32 s56, s66, 5120
    buffer_load_dwordx4 v2, s[36:39], s56 offen offset:2048 lds
    s_add_u32 s56, s66, 7680
    buffer_load_dwordx4 v2, s[36:39], s56 offen offset:3072 lds
    s_waitcnt vmcnt(8)
    s_barrier
    s_bfe_u32 s57, s71, 0x40000
    s_lshr_b32 s65, s57, 2
    s_mul_i32 s65, s65, 15872
    s_lshl_b32 s67, s57, 7
    s_add_u32 s65, s65, s67
    s_add_u32 s65, s65, s63
    s_mul_i32 s66, s57, 57344
    s_add_u32 s66, s66, s64
    s_add_u32 m0, s60, 98304
    s_nop 0
    buffer_load_dwordx4 v4, s[32:35], s65 offen lds
    s_add_u32 s56, s65, 3072
    buffer_load_dwordx4 v5, s[32:35], s56 offen offset:1024 lds
    s_add_u32 s56, s65, 6144
    buffer_load_dwordx4 v4, s[32:35], s56 offen offset:2048 lds
    s_add_u32 s56, s65, 9216
    buffer_load_dwordx4 v5, s[32:35], s56 offen offset:3072 lds
    s_add_u32 m0, s60, 114688
    s_nop 0
    buffer_load_dwordx4 v6, s[36:39], s66 offen lds
    s_add_u32 s56, s66, 2560
    buffer_load_dwordx4 v6, s[36:39], s56 offen offset:1024 lds
    s_add_u32 s56, s66, 5120
    buffer_load_dwordx4 v2, s[36:39], s56 offen offset:2048 lds
    s_add_u32 s56, s66, 7680
    buffer_load_dwordx4 v2, s[36:39], s56 offen offset:3072 lds
    s_waitcnt vmcnt(8)
    s_barrier
    s_bfe_u32 s57, s71, 0x40004
    s_lshr_b32 s65, s57, 2
    s_mul_i32 s65, s65, 15872
    s_lshl_b32 s67, s57, 7
    s_add_u32 s65, s65, s67
    s_add_u32 s65, s65, s63
    s_mul_i32 s66, s57, 57344
    s_add_u32 s66, s66, s64
    s_add_u32 m0, s60, 131072
    s_nop 0
    buffer_load_dwordx4 v4, s[32:35], s65 offen lds
    s_add_u32 s56, s65, 3072
    buffer_load_dwordx4 v5, s[32:35], s56 offen offset:1024 lds
    s_add_u32 s56, s65, 6144
    buffer_load_dwordx4 v4, s[32:35], s56 offen offset:2048 lds
    s_add_u32 s56, s65, 9216
    buffer_load_dwordx4 v5, s[32:35], s56 offen offset:3072 lds
    s_add_u32 m0, s60, 147456
    s_nop 0
    buffer_load_dwordx4 v6, s[36:39], s66 offen lds
    s_add_u32 s56, s66, 2560
    buffer_load_dwordx4 v6, s[36:39], s56 offen offset:1024 lds
    s_add_u32 s56, s66, 5120
    buffer_load_dwordx4 v2, s[36:39], s56 offen offset:2048 lds
    s_add_u32 s56, s66, 7680
    buffer_load_dwordx4 v2, s[36:39], s56 offen offset:3072 lds
    s_waitcnt vmcnt(8)
    s_barrier
    s_bfe_u32 s57, s71, 0x40008
    s_lshr_b32 s65, s57, 2
    s_mul_i32 s65, s65, 15872
    s_lshl_b32 s67, s57, 7
    s_add_u32 s65, s65, s67
    s_add_u32 s65, s65, s63
    s_mul_i32 s66, s57, 57344
    s_add_u32 s66, s66, s64
    s_mov_b32 m0, s60
    s_nop 0
    buffer_load_dwordx4 v4, s[32:35], s65 offen lds
    s_add_u32 s56, s65, 3072
    buffer_load_dwordx4 v5, s[32:35], s56 offen offset:1024 lds
    s_add_u32 s56, s65, 6144
    buffer_load_dwordx4 v4, s[32:35], s56 offen offset:2048 lds
    s_add_u32 s56, s65, 9216
    buffer_load_dwordx4 v5, s[32:35], s56 offen offset:3072 lds
    s_add_u32 m0, s60, 16384
    s_nop 0
    buffer_load_dwordx4 v6, s[36:39], s66 offen lds
    s_add_u32 s56, s66, 2560
    buffer_load_dwordx4 v6, s[36:39], s56 offen offset:1024 lds
    s_add_u32 s56, s66, 5120
    buffer_load_dwordx4 v2, s[36:39], s56 offen offset:2048 lds
    s_add_u32 s56, s66, 7680
    buffer_load_dwordx4 v2, s[36:39], s56 offen offset:3072 lds
    s_mov_b32 s62, 524288
L_ep1:
    v_readfirstlane_b32 s61, v8
    s_nop 1
    s_cmp_lg_u32 s61, 0
    s_cbranch_scc1 L_ep1_ok
    s_sub_u32 s62, s62, 1
    s_cbranch_scc1 L_ep1_ok
    buffer_load_dword v8, v7, s[48:51], 0 offen sc1
    s_waitcnt vmcnt(0)
    s_branch L_ep1
L_ep1_ok:
    v_and_b32 v62, 1, v1
    v_mul_u32_u24 v62, 15, v62
    v_add_u32 v62, 1, v62
    v_lshrrev_b32 v62, v62, s61
    v_bfe_u32 v63, v62, 0, 2
    v_bfe_u32 v12, v62, 2, 2
    v_lshlrev_b32 v63, 14, v63
    v_lshl_or_b32 v12, v12, 30, v63
    v_bfe_u32 v63, v62, 4, 2
    v_bfe_u32 v13, v62, 6, 2
    v_lshlrev_b32 v63, 14, v63
    v_lshl_or_b32 v13, v13, 30, v63
    v_bfe_u32 v63, v62, 8, 2
    v_bfe_u32 v14, v62, 10, 2
    v_lshlrev_b32 v63, 14, v63
    v_lshl_or_b32 v14, v14, 30, v63
    v_bfe_u32 v63, v62, 12, 2
    v_bfe_u32 v15, v62, 14, 2
    v_lshlrev_b32 v63, 14, v63
    v_lshl_or_b32 v15, v15, 30, v63
    s_waitcnt vmcnt(8)
    s_barrier
    s_bfe_u32 s57, s71, 0x4000c
    s_lshr_b32 s65, s57, 2
    s_mul_i32 s65, s65, 15872
    s_lshl_b32 s67, s57, 7
    s_add_u32 s65, s65, s67
    s_add_u32 s65, s65, s63
    s_mul_i32 s66, s57, 57344
    s_add_u32 s66, s66, s64
    s_add_u32 m0, s60, 32768
    s_nop 0
    buffer_load_dwordx4 v4, s[32:35], s65 offen lds
    s_add_u32 s56, s65, 3072
    buffer_load_dwordx4 v5, s[32:35], s56 offen offset:1024 lds
    s_add_u32 s56, s65, 6144
    buffer_load_dwordx4 v4, s[32:35], s56 offen offset:2048 lds
    s_add_u32 s56, s65, 9216
    buffer_load_dwordx4 v5, s[32:35], s56 offen offset:3072 lds
    s_add_u32 m0, s60, 49152
    s_nop 0
    buffer_load_dwordx4 v6, s[36:39], s66 offen lds
    s_add_u32 s56, s66, 2560
    buffer_load_dwordx4 v6, s[36:39], s56 offen offset:1024 lds
    s_add_u32 s56, s66, 5120
    buffer_load_dwordx4 v2, s[36:39], s56 offen offset:2048 lds
    s_add_u32 s56, s66, 7680
    buffer_load_dwordx4 v2, s[36:39], s56 offen offset:3072 lds
    v_add_u32 v10, s60, v11
    v_add_u32 v10, 32768, v10
    s_add_u32 s58, s25, 0
    s_and_b32 s58, s58, 3
    s_lshr_b32 s56, s63, 14
    s_add_u32 s56, s56, s58
    s_lshl_b32 s40, s56, 11
    s_lshl_b32 s56, s56, 7
    s_add_u32 s28, s56, 6291456
    s_lshl_b32 s59, s58, 1
    s_lshr_b32 s59, s15, s59
    s_and_b32 s59, s59, 3
    s_lshl_b32 s59, s59, 11
    v_add_u32 v48, s59, v10
    s_add_u32 s58, s25, 1
    s_and_b32 s58, s58, 3
    s_lshr_b32 s56, s63, 14
    s_add_u32 s56, s56, s58
    s_lshl_b32 s41, s56, 11
    s_lshl_b32 s56, s56, 7
    s_add_u32 s30, s56, 6291456
    s_lshl_b32 s59, s58, 1
    s_lshr_b32 s59, s15, s59
    s_and_b32 s59, s59, 3
    s_lshl_b32 s59, s59, 11
    v_add_u32 v49, s59, v10
    s_add_u32 s58, s25, 2
    s_and_b32 s58, s58, 3
    s_lshr_b32 s56, s63, 14
    s_add_u32 s56, s56, s58
    s_lshl_b32 s42, s56, 11
    s_lshl_b32 s56, s56, 7
    s_add_u32 s31, s56, 6291456
    s_lshl_b32 s59, s58, 1
    s_lshr_b32 s59, s15, s59
    s_and_b32 s59, s59, 3
    s_lshl_b32 s59, s59, 11
    v_add_u32 v50, s59, v10
    s_add_u32 s58, s25, 3
    s_and_b32 s58, s58, 3
    s_lshr_b32 s56, s63, 14
    s_add_u32 s56, s56, s58
    s_lshl_b32 s43, s56, 11
    s_lshl_b32 s56, s56, 7
    s_add_u32 s20, s56, 6291456
    s_lshl_b32 s59, s58, 1
    s_lshr_b32 s59, s15, s59
    s_and_b32 s59, s59, 3
    s_lshl_b32 s59, s59, 11
    v_add_u32 v51, s59, v10
    s_lshl_b32 s56, s24, 2
    s_add_u32 s56, s56, s25
    s_lshl_b32 s56, s56, 2
    s_add_u32 s56, s56, s23
    s_mul_i32 s56, s56, 12
    s_add_u32 s56, s56, s26
    s_mul_i32 s21, s56, 2304
    s_add_u32 s21, s21, 1048576
    s_lshl_b32 s56, s56, 7
    s_add_u32 s3, s56, 7340032
    v_and_b32 v62, 15, v1
    v_mul_u32_u24 v62, 896, v62
    v_bfe_u32 v63, v1, 4, 1
    v_lshl_add_u32 v62, v63, 5, v62
    v_lshrrev_b32 v63, 5, v1
    v_lshl_add_u32 v57, v63, 4, v62
    s_lshr_b32 s56, s23, 1
    s_and_b32 s57, s23, 1
    s_and_b32 s58, s26, 1
    s_lshl_b32 s59, s58, 1
    s_add_u32 s59, s59, s57
    s_add_u32 s58, s58, 2
    s_cmp_eq_u32 s25, 3
    s_cselect_b32 s56, s57, s56
    s_cselect_b32 s59, s58, s59
    s_and_b32 s57, s26, 2
    s_add_u32 s56, s56, s57
    s_lshl_b32 s57, s24, 2
    s_add_u32 s56, s56, s57
    s_mul_i32 s27, s56, 28672
    s_lshl_b32 s57, s25, 8
    s_min_u32 s57, s57, 640
    s_add_u32 s27, s27, s57
    s_lshl_b32 s57, s59, 6
    s_add_u32 s27, s27, s57
    v_add_u32 v58, 65536, v11
    v_lshlrev_b32 v59, 2, v1
    v_mov_b32 v60, 0x3f80
    v_mov_b32 v61, 0x3f800000
    s_waitcnt vmcnt(8)
    s_barrier
    s_bfe_u32 s57, s71, 0x40010
    s_lshr_b32 s65, s57, 2
    s_mul_i32 s65, s65, 15872
    s_lshl_b32 s67, s57, 7
    s_add_u32 s65, s65, s67
    s_add_u32 s65, s65, s63
    s_mul_i32 s66, s57, 57344
    s_add_u32 s66, s66, s64
    s_add_u32 m0, s60, 65536
    s_nop 0
    buffer_load_dwordx4 v4, s[32:35], s65 offen lds
    s_add_u32 s56, s65, 3072
    buffer_load_dwordx4 v5, s[32:35], s56 offen offset:1024 lds
    s_add_u32 s56, s65, 6144
    buffer_load_dwordx4 v4, s[32:35], s56 offen offset:2048 lds
    s_add_u32 s56, s65, 9216
    buffer_load_dwordx4 v5, s[32:35], s56 offen offset:3072 lds
    s_add_u32 m0, s60, 81920
    s_nop 0
    buffer_load_dwordx4 v6, s[36:39], s66 offen lds
    s_add_u32 s56, s66, 2560
    buffer_load_dwordx4 v6, s[36:39], s56 offen offset:1024 lds
    s_add_u32 s56, s66, 5120
    buffer_load_dwordx4 v2, s[36:39], s56 offen offset:2048 lds
    s_add_u32 s56, s66, 7680
    buffer_load_dwordx4 v2, s[36:39], s56 offen offset:3072 lds
    s_waitcnt vmcnt(8)
    s_barrier
    s_bfe_u32 s57, s71, 0x40014
    s_lshr_b32 s65, s57, 2
    s_mul_i32 s65, s65, 15872
    s_lshl_b32 s67, s57, 7
    s_add_u32 s65, s65, s67
    s_add_u32 s65, s65, s63
    s_mul_i32 s66, s57, 57344
    s_add_u32 s66, s66, s64
    s_add_u32 m0, s60, 98304
    s_nop 0
    buffer_load_dwordx4 v4, s[32:35], s65 offen lds
    s_add_u32 s56, s65, 3072
    buffer_load_dwordx4 v5, s[32:35], s56 offen offset:1024 lds
    s_add_u32 s56, s65, 6144
    buffer_load_dwordx4 v4, s[32:35], s56 offen offset:2048 lds
    s_add_u32 s56, s65, 9216
    buffer_load_dwordx4 v5, s[32:35], s56 offen offset:3072 lds
    s_add_u32 m0, s60, 114688
    s_nop 0
    buffer_load_dwordx4 v6, s[36:39], s66 offen lds
    s_add_u32 s56, s66, 2560
    buffer_load_dwordx4 v6, s[36:39], s56 offen offset:1024 lds
    s_add_u32 s56, s66, 5120
    buffer_load_dwordx4 v2, s[36:39], s56 offen offset:2048 lds
    s_add_u32 s56, s66, 7680
    buffer_load_dwordx4 v2, s[36:39], s56 offen offset:3072 lds
    s_waitcnt vmcnt(8)
    s_barrier
    s_bfe_u32 s57, s71, 0x40018
    s_lshr_b32 s65, s57, 2
    s_mul_i32 s65, s65, 15872
    s_lshl_b32 s67, s57, 7
    s_add_u32 s65, s65, s67
    s_add_u32 s65, s65, s63
    s_mul_i32 s66, s57, 57344
    s_add_u32 s66, s66, s64
    s_add_u32 m0, s60, 131072
    s_nop 0
    buffer_load_dwordx4 v4, s[32:35], s65 offen lds
    s_add_u32 s56, s65, 3072
    buffer_load_dwordx4 v5, s[32:35], s56 offen offset:1024 lds
    s_add_u32 s56, s65, 6144
    buffer_load_dwordx4 v4, s[32:35], s56 offen offset:2048 lds
    s_add_u32 s56, s65, 9216
    buffer_load_dwordx4 v5, s[32:35], s56 offen offset:3072 lds
    s_add_u32 m0, s60, 147456
    s_nop 0
    buffer_load_dwordx4 v6, s[36:39], s66 offen lds
    s_add_u32 s56, s66, 2560
    buffer_load_dwordx4 v6, s[36:39], s56 offen offset:1024 lds
    s_add_u32 s56, s66, 5120
    buffer_load_dwordx4 v2, s[36:39], s56 offen offset:2048 lds
    s_add_u32 s56, s66, 7680
    buffer_load_dwordx4 v2, s[36:39], s56 offen offset:3072 lds
    s_waitcnt vmcnt(8)
    s_barrier
    s_bfe_u32 s57, s71, 0x4001c
    s_lshr_b32 s65, s57, 2
    s_mul_i32 s65, s65, 15872
    s_lshl_b32 s67, s57, 7
    s_add_u32 s65, s65, s67
    s_add_u32 s65, s65, s63
    s_mul_i32 s66, s57, 57344
    s_add_u32 s66, s66, s64
    s_mov_b32 m0, s60
    s_nop 0
    buffer_load_dwordx4 v4, s[32:35], s65 offen lds
    s_add_u32 s56, s65, 3072
    buffer_load_dwordx4 v5, s[32:35], s56 offen offset:1024 lds
    s_add_u32 s56, s65, 6144
    buffer_load_dwordx4 v4, s[32:35], s56 offen offset:2048 lds
    s_add_u32 s56, s65, 9216
    buffer_load_dwordx4 v5, s[32:35], s56 offen offset:3072 lds
    s_add_u32 m0, s60, 16384
    s_nop 0
    buffer_load_dwordx4 v6, s[36:39], s66 offen lds
    s_add_u32 s56, s66, 2560
    buffer_load_dwordx4 v6, s[36:39], s56 offen offset:1024 lds
    s_add_u32 s56, s66, 5120
    buffer_load_dwordx4 v2, s[36:39], s56 offen offset:2048 lds
    s_add_u32 s56, s66, 7680
    buffer_load_dwordx4 v2, s[36:39], s56 offen offset:3072 lds
    s_buffer_load_dword s68, s[44:47], s28 glc
    s_buffer_load_dword s69, s[44:47], s30 glc
    s_buffer_load_dword s58, s[44:47], s31 glc
    s_buffer_load_dword s59, s[44:47], s20 glc
    s_waitcnt vmcnt(8)
    s_barrier
    s_buffer_load_dword s68, s[44:47], s28 glc
    s_buffer_load_dword s69, s[44:47], s30 glc
    s_buffer_load_dword s58, s[44:47], s31 glc
    s_buffer_load_dword s59, s[44:47], s20 glc
    s_waitcnt vmcnt(0)
    s_barrier
    s_mov_b32 s62, 524288
L_ph_s0:
    s_waitcnt lgkmcnt(0)
    s_cmp_eq_u32 s68, s61
    s_cbranch_scc1 L_ph_s0_go
    s_buffer_load_dword s68, s[44:47], s28 glc
    s_buffer_load_dword s69, s[44:47], s30 glc
    s_buffer_load_dword s58, s[44:47], s31 glc
    s_buffer_load_dword s59, s[44:47], s20 glc
    s_sub_u32 s62, s62, 1
    s_cmp_gt_i32 s62, 0
    s_cbranch_scc1 L_ph_s0
L_ph_s0_go:
    buffer_load_dwordx4 v[16:19], v9, s[44:47], s40 offen offset:0 sc1
    buffer_load_dwordx4 v[20:23], v9, s[44:47], s40 offen offset:1024 sc1
L_ph_s1:
    s_waitcnt lgkmcnt(0)
    s_cmp_eq_u32 s69, s61
    s_cbranch_scc1 L_ph_s1_go
    s_buffer_load_dword s69, s[44:47], s30 glc
    s_buffer_load_dword s58, s[44:47], s31 glc
    s_buffer_load_dword s59, s[44:47], s20 glc
    s_sub_u32 s62, s62, 1
    s_cmp_gt_i32 s62, 0
    s_cbranch_scc1 L_ph_s1
L_ph_s1_go:
    buffer_load_dwordx4 v[24:27], v9, s[44:47], s41 offen offset:0 sc1
    buffer_load_dwordx4 v[28:31], v9, s[44:47], s41 offen offset:1024 sc1
L_ph_s2:
    s_waitcnt lgkmcnt(0)
    s_cmp_eq_u32 s58, s61
    s_cbranch_scc1 L_ph_s2_go
    s_buffer_load_dword s58, s[44:47], s31 glc
    s_buffer_load_dword s59, s[44:47], s20 glc
    s_sub_u32 s62, s62, 1
    s_cmp_gt_i32 s62, 0
    s_cbranch_scc1 L_ph_s2
L_ph_s2_go:
    buffer_load_dwordx4 v[32:35], v9, s[44:47], s42 offen offset:0 sc1
    buffer_load_dwordx4 v[36:39], v9, s[44:47], s42 offen offset:1024 sc1
L_ph_s3:
    s_waitcnt lgkmcnt(0)
    s_cmp_eq_u32 s59, s61
    s_cbranch_scc1 L_ph_s3_go
    s_buffer_load_dword s59, s[44:47], s20 glc
    s_sub_u32 s62, s62, 1
    s_cmp_gt_i32 s62, 0
    s_cbranch_scc1 L_ph_s3
L_ph_s3_go:
    buffer_load_dwordx4 v[40:43], v9, s[44:47], s43 offen offset:0 sc1
    buffer_load_dwordx4 v[44:47], v9, s[44:47], s43 offen offset:1024 sc1
    s_mov_b32 s62, 524288
    s_waitcnt vmcnt(6)
L_ph2_chk:
    v_xor_b32 v16, v12, v16
    v_xor_b32 v17, v13, v17
    v_xor_b32 v18, v14, v18
    v_xor_b32 v19, v15, v19
    v_xor_b32 v20, v12, v20
    v_xor_b32 v21, v13, v21
    v_xor_b32 v22, v14, v22
    v_xor_b32 v23, v15, v23
    v_or3_b32 v2, v16, v17, v18
    v_or3_b32 v3, v19, v20, v21
    v_or3_b32 v2, v2, v22, v23
    v_or_b32 v2, v2, v3
    v_and_b32 v2, 0xc000c000, v2
    v_cmp_ne_u32 vcc, 0, v2
    ds_write_b128 v48, v[16:19]
    ds_write_b128 v48, v[20:23] offset:1024
    s_cmp_eq_u64 vcc, 0
    s_cbranch_scc0 L_ph2_fix
L_ph2_ok:
    s_waitcnt vmcnt(4)
L_ph3_chk:
    v_xor_b32 v24, v12, v24
    v_xor_b32 v25, v13, v25
    v_xor_b32 v26, v14, v26
    v_xor_b32 v27, v15, v27
    v_xor_b32 v28, v12, v28
    v_xor_b32 v29, v13, v29
    v_xor_b32 v30, v14, v30
    v_xor_b32 v31, v15, v31
    v_or3_b32 v2, v24, v25, v26
    v_or3_b32 v3, v27, v28, v29
    v_or3_b32 v2, v2, v30, v31
    v_or_b32 v2, v2, v3
    v_and_b32 v2, 0xc000c000, v2
    v_cmp_ne_u32 vcc, 0, v2
    ds_write_b128 v49, v[24:27]
    ds_write_b128 v49, v[28:31] offset:1024
    s_cmp_eq_u64 vcc, 0
    s_cbranch_scc0 L_ph3_fix
L_ph3_ok:
    s_waitcnt vmcnt(2)
L_ph4_chk:
    v_xor_b32 v32, v12, v32
    v_xor_b32 v33, v13, v33
    v_xor_b32 v34, v14, v34
    v_xor_b32 v35, v15, v35
    v_xor_b32 v36, v12, v36
    v_xor_b32 v37, v13, v37
    v_xor_b32 v38, v14, v38
    v_xor_b32 v39, v15, v39
    v_or3_b32 v2, v32, v33, v34
    v_or3_b32 v3, v35, v36, v37
    v_or3_b32 v2, v2, v38, v39
    v_or_b32 v2, v2, v3
    v_and_b32 v2, 0xc000c000, v2
    v_cmp_ne_u32 vcc, 0, v2
    ds_write_b128 v50, v[32:35]
    ds_write_b128 v50, v[36:39] offset:1024
    s_cmp_eq_u64 vcc, 0
    s_cbranch_scc0 L_ph4_fix
L_ph4_ok:
    s_waitcnt vmcnt(0)
L_ph5_chk:
    v_xor_b32 v40, v12, v40
    v_xor_b32 v41, v13, v41
    v_xor_b32 v42, v14, v42
    v_xor_b32 v43, v15, v43
    v_xor_b32 v44, v12, v44
    v_xor_b32 v45, v13, v45
    v_xor_b32 v46, v14, v46
    v_xor_b32 v47, v15, v47
    v_or3_b32 v2, v40, v41, v42
    v_or3_b32 v3, v43, v44, v45
    v_or3_b32 v2, v2, v46, v47
    v_or_b32 v2, v2, v3
    v_and_b32 v2, 0xc000c000, v2
    v_cmp_ne_u32 vcc, 0, v2
    ds_write_b128 v51, v[40:43]
    ds_write_b128 v51, v[44:47] offset:1024
    s_cmp_eq_u64 vcc, 0
    s_cbranch_scc0 L_ph5_fix
L_ph5_ok:
    s_add_u32 s28, s3, 512
    s_add_u32 s30, s3, 1024
    s_waitcnt lgkmcnt(0)
    s_buffer_load_dword s68, s[44:47], s3 glc
    s_buffer_load_dword s69, s[44:47], s28 glc
    s_buffer_load_dword s58, s[44:47], s30 glc
    s_barrier
    s_lshr_b32 s56, s23, 1
    s_xor_b32 s56, s56, s26
    s_and_b32 s56, s56, 1
    s_cmp_eq_u32 s25, 3
    s_cselect_b32 s56, s56, 0
    s_cmp_lg_u32 s56, 0
    s_cbranch_scc1 L_Uquit
    s_add_u32 s31, s27, 14336
    s_mov_b32 s62, 524288
L_xh_s0:
    s_waitcnt lgkmcnt(0)
    s_cmp_eq_u32 s68, s61
    s_cbranch_scc1 L_xh_s0_go
    s_buffer_load_dword s68, s[44:47], s3 glc
    s_buffer_load_dword s69, s[44:47], s28 glc
    s_buffer_load_dword s58, s[44:47], s30 glc
    s_sub_u32 s62, s62, 1
    s_cmp_gt_i32 s62, 0
    s_cbranch_scc1 L_xh_s0
L_xh_s0_go:
    s_add_u32 s56, s21, 0
    buffer_load_dwordx4 v[80:83], v9, s[44:47], s56 offen offset:0 sc1
    buffer_load_dwordx4 v[84:87], v9, s[44:47], s56 offen offset:1024 sc1
    buffer_load_dword v88, v59, s[44:47], s56 offen offset:2048 sc1
L_xh_s1:
    s_waitcnt lgkmcnt(0)
    s_cmp_eq_u32 s69, s61
    s_cbranch_scc1 L_xh_s1_go
    s_buffer_load_dword s69, s[44:47], s28 glc
    s_buffer_load_dword s58, s[44:47], s30 glc
    s_sub_u32 s62, s62, 1
    s_cmp_gt_i32 s62, 0
    s_cbranch_scc1 L_xh_s1
L_xh_s1_go:
    s_add_u32 s56, s21, 9216
    buffer_load_dwordx4 v[96:99], v9, s[44:47], s56 offen offset:0 sc1
    buffer_load_dwordx4 v[100:103], v9, s[44:47], s56 offen offset:1024 sc1
    buffer_load_dword v104, v59, s[44:47], s56 offen offset:2048 sc1
L_xh_s2:
    s_waitcnt lgkmcnt(0)
    s_cmp_eq_u32 s58, s61
    s_cbranch_scc1 L_xh_s2_go
    s_buffer_load_dword s58, s[44:47], s30 glc
    s_sub_u32 s62, s62, 1
    s_cmp_gt_i32 s62, 0
    s_cbranch_scc1 L_xh_s2
L_xh_s2_go:
    s_add_u32 s56, s21, 18432
    buffer_load_dwordx4 v[112:115], v9, s[44:47], s56 offen offset:0 sc1
    buffer_load_dwordx4 v[116:119], v9, s[44:47], s56 offen offset:1024 sc1
    buffer_load_dword v120, v59, s[44:47], s56 offen offset:2048 sc1
    s_mov_b32 s62, 524288
    s_barrier
    ds_read_b128 v[64:67], v58
    ds_read_b128 v[68:71], v58 offset:1024
    ds_read_b128 v[72:75], v58 offset:2048
    ds_read_b128 v[76:79], v58 offset:3072
    s_waitcnt vmcnt(6)
L_xh6_chk:
    v_bitop3_b32 v52, v80, v81, v82 bitop3:0x96
    v_bitop3_b32 v53, v83, v84, v85 bitop3:0x96
    v_bitop3_b32 v54, v86, v87, v88 bitop3:0x96
    v_bitop3_b32 v52, v52, v53, v54 bitop3:0x96
    v_cmp_ne_u32 vcc, s61, v52
    s_nop 1
    s_cmp_eq_u64 vcc, 0
    s_cbranch_scc0 L_xh6_fix
L_xh6_ok:
    s_waitcnt lgkmcnt(3)
    v_dot2_f32_bf16 v64, v80, v60, v64
    v_dot2_f32_bf16 v65, v80, v61, v65
    v_dot2_f32_bf16 v66, v81, v60, v66
    v_dot2_f32_bf16 v67, v81, v61, v67
    s_waitcnt lgkmcnt(2)
    v_dot2_f32_bf16 v68, v82, v60, v68
    v_dot2_f32_bf16 v69, v82, v61, v69
    v_dot2_f32_bf16 v70, v83, v60, v70
    v_dot2_f32_bf16 v71, v83, v61, v71
    s_waitcnt lgkmcnt(1)
    v_dot2_f32_bf16 v72, v84, v60, v72
    v_dot2_f32_bf16 v73, v84, v61, v73
    v_dot2_f32_bf16 v74, v85, v60, v74
    v_dot2_f32_bf16 v75, v85, v61, v75
    s_waitcnt lgkmcnt(0)
    v_dot2_f32_bf16 v76, v86, v60, v76
    v_dot2_f32_bf16 v77, v86, v61, v77
    v_dot2_f32_bf16 v78, v87, v60, v78
    v_dot2_f32_bf16 v79, v87, v61, v79
    s_waitcnt vmcnt(3)
L_xh7_chk:
    v_bitop3_b32 v52, v96, v97, v98 bitop3:0x96
    v_bitop3_b32 v53, v99, v100, v101 bitop3:0x96
    v_bitop3_b32 v54, v102, v103, v104 bitop3:0x96
    v_bitop3_b32 v52, v52, v53, v54 bitop3:0x96
    v_cmp_ne_u32 vcc, s61, v52
    s_nop 1
    s_cmp_eq_u64 vcc, 0
    s_cbranch_scc0 L_xh7_fix
L_xh7_ok:
    v_dot2_f32_bf16 v64, v96, v60, v64
    v_dot2_f32_bf16 v65, v96, v61, v65
    v_dot2_f32_bf16 v66, v97, v60, v66
    v_dot2_f32_bf16 v67, v97, v61, v67
    v_dot2_f32_bf16 v68, v98, v60, v68
    v_dot2_f32_bf16 v69, v98, v61, v69
    v_dot2_f32_bf16 v70, v99, v60, v70
    v_dot2_f32_bf16 v71, v99, v61, v71
    v_dot2_f32_bf16 v72, v100, v60, v72
    v_dot2_f32_bf16 v73, v100, v61, v73
    v_dot2_f32_bf16 v74, v101, v60, v74
    v_dot2_f32_bf16 v75, v101, v61, v75
    v_dot2_f32_bf16 v76, v102, v60, v76
    v_dot2_f32_bf16 v77, v102, v61, v77
    v_dot2_f32_bf16 v78, v103, v60, v78
    v_dot2_f32_bf16 v79, v103, v61, v79
    s_waitcnt vmcnt(0)
L_xh8_chk:
    v_bitop3_b32 v52, v112, v113, v114 bitop3:0x96
    v_bitop3_b32 v53, v115, v116, v117 bitop3:0x96
    v_bitop3_b32 v54, v118, v119, v120 bitop3:0x96
    v_bitop3_b32 v52, v52, v53, v54 bitop3:0x96
    v_cmp_ne_u32 vcc, s61, v52
    s_nop 1
    s_cmp_eq_u64 vcc, 0
    s_cbranch_scc0 L_xh8_fix
L_xh8_ok:
    v_dot2_f32_bf16 v64, v112, v60, v64
    v_dot2_f32_bf16 v65, v112, v61, v65
    v_dot2_f32_bf16 v66, v113, v60, v66
    v_dot2_f32_bf16 v67, v113, v61, v67
    v_dot2_f32_bf16 v68, v114, v60, v68
    v_dot2_f32_bf16 v69, v114, v61, v69
    v_dot2_f32_bf16 v70, v115, v60, v70
    v_dot2_f32_bf16 v71, v115, v61, v71
    v_dot2_f32_bf16 v72, v116, v60, v72
    v_dot2_f32_bf16 v73, v116, v61, v73
    v_dot2_f32_bf16 v74, v117, v60, v74
    v_dot2_f32_bf16 v75, v117, v61, v75
    v_dot2_f32_bf16 v76, v118, v60, v76
    v_dot2_f32_bf16 v77, v118, v61, v77
    v_dot2_f32_bf16 v78, v119, v60, v78
    v_dot2_f32_bf16 v79, v119, v61, v79
    s_nop 2
    v_cvt_pk_bf16_f32 v64, v64, v65
    v_cvt_pk_bf16_f32 v65, v66, v67
    v_cvt_pk_bf16_f32 v66, v68, v69
    v_cvt_pk_bf16_f32 v67, v70, v71
    s_nop 0
    v_permlane16_swap_b32 v64, v66
    v_permlane16_swap_b32 v65, v67
    buffer_store_dwordx4 v[64:67], v57, s[52:55], s27 offen
    v_cvt_pk_bf16_f32 v68, v72, v73
    v_cvt_pk_bf16_f32 v69, v74, v75
    v_cvt_pk_bf16_f32 v70, v76, v77
    v_cvt_pk_bf16_f32 v71, v78, v79
    s_nop 0
    v_permlane16_swap_b32 v68, v70
    v_permlane16_swap_b32 v69, v71
    buffer_store_dwordx4 v[68:71], v57, s[52:55], s31 offen
L_Uquit:
    s_endpgm
L_ph2_fix:
    s_sub_u32 s62, s62, 1
    s_cbranch_scc1 L_ph2_ok
    buffer_load_dwordx4 v[16:19], v9, s[44:47], s40 offen offset:0 sc1
    buffer_load_dwordx4 v[20:23], v9, s[44:47], s40 offen offset:1024 sc1
    s_waitcnt vmcnt(0)
    s_branch L_ph2_chk
L_ph3_fix:
    s_sub_u32 s62, s62, 1
    s_cbranch_scc1 L_ph3_ok
    buffer_load_dwordx4 v[24:27], v9, s[44:47], s41 offen offset:0 sc1
    buffer_load_dwordx4 v[28:31], v9, s[44:47], s41 offen offset:1024 sc1
    s_waitcnt vmcnt(0)
    s_branch L_ph3_chk
L_ph4_fix:
    s_sub_u32 s62, s62, 1
    s_cbranch_scc1 L_ph4_ok
    buffer_load_dwordx4 v[32:35], v9, s[44:47], s42 offen offset:0 sc1
    buffer_load_dwordx4 v[36:39], v9, s[44:47], s42 offen offset:1024 sc1
    s_waitcnt vmcnt(0)
    s_branch L_ph4_chk
L_ph5_fix:
    s_sub_u32 s62, s62, 1
    s_cbranch_scc1 L_ph5_ok
    buffer_load_dwordx4 v[40:43], v9, s[44:47], s43 offen offset:0 sc1
    buffer_load_dwordx4 v[44:47], v9, s[44:47], s43 offen offset:1024 sc1
    s_waitcnt vmcnt(0)
    s_branch L_ph5_chk
L_xh6_fix:
    s_sub_u32 s62, s62, 1
    s_cbranch_scc1 L_xh6_ok
    s_add_u32 s56, s21, 0
    buffer_load_dwordx4 v[80:83], v9, s[44:47], s56 offen offset:0 sc1
    buffer_load_dwordx4 v[84:87], v9, s[44:47], s56 offen offset:1024 sc1
    buffer_load_dword v88, v59, s[44:47], s56 offen offset:2048 sc1
    s_waitcnt vmcnt(0)
    s_branch L_xh6_chk
L_xh7_fix:
    s_sub_u32 s62, s62, 1
    s_cbranch_scc1 L_xh7_ok
    s_add_u32 s56, s21, 9216
    buffer_load_dwordx4 v[96:99], v9, s[44:47], s56 offen offset:0 sc1
    buffer_load_dwordx4 v[100:103], v9, s[44:47], s56 offen offset:1024 sc1
    buffer_load_dword v104, v59, s[44:47], s56 offen offset:2048 sc1
    s_waitcnt vmcnt(0)
    s_branch L_xh7_chk
L_xh8_fix:
    s_sub_u32 s62, s62, 1
    s_cbranch_scc1 L_xh8_ok
    s_add_u32 s56, s21, 18432
    buffer_load_dwordx4 v[112:115], v9, s[44:47], s56 offen offset:0 sc1
    buffer_load_dwordx4 v[116:119], v9, s[44:47], s56 offen offset:1024 sc1
    buffer_load_dword v120, v59, s[44:47], s56 offen offset:2048 sc1
    s_waitcnt vmcnt(0)
    s_branch L_xh8_chk
.p2align 12
L_Srest:
    s_and_b32 s56, s2, 7
    s_and_b32 s57, s22, 1
    s_lshl_b32 s27, s56, 1
    s_add_u32 s27, s27, s57
    s_bfe_u32 s24, s22, 0x30001
    s_mul_i32 s57, s57, 3
    s_add_u32 s56, s56, s57
    s_add_u32 s28, s56, s24
    s_sub_u32 s57, s28, 6
    s_cselect_b32 s28, s28, s57
    s_sub_u32 s57, s28, 6
    s_cselect_b32 s28, s28, s57
    s_mov_b32 s40, s6
    s_and_b32 s41, s7, 0xffff
    s_mov_b32 s42, 8388608
    s_mov_b32 s43, 0x20000
    v_lshl_add_u32 v8, v13, 9, v14
    v_xor_b32 v9, 64, v8
    s_lshl_b32 s62, s24, 2
    s_add_u32 s62, s62, s26
    s_lshl_b32 s62, s62, 4
    s_add_u32 s62, s62, s27
    s_lshl_b32 s62, s62, 14
    s_add_u32 s67, s28, 0
    s_sub_u32 s57, s67, 6
    s_cselect_b32 s67, s67, s57
    s_lshl_b32 s66, s67, 7
    s_add_u32 s66, s66, s64
    s_add_u32 m0, s60, 114688
    s_add_u32 s56, s66, 128
    buffer_load_dwordx4 v6, s[32:35], s56 offen lds
    s_add_u32 s56, s66, 6272
    buffer_load_dwordx4 v7, s[32:35], s56 offen offset:1024 lds
    s_waitcnt vmcnt(6)
    s_barrier
    s_add_u32 s56, s66, 12416
    buffer_load_dwordx4 v6, s[32:35], s56 offen offset:2048 lds
    s_add_u32 s56, s66, 18560
    buffer_load_dwordx4 v7, s[32:35], s56 offen offset:3072 lds
    s_add_u32 s67, s28, 0
    s_sub_u32 s57, s67, 6
    s_cselect_b32 s67, s67, s57
    s_lshl_b32 s65, s67, 19
    s_add_u32 s65, s65, s63
    s_add_u32 m0, s60, 32768
    s_add_u32 s56, s65, 524288
    buffer_load_dwordx4 v4, s[36:39], s56 offen lds
    s_add_u32 s56, s65, 539648
    buffer_load_dwordx4 v5, s[36:39], s56 offen offset:1024 lds
    s_waitcnt vmcnt(6)
    s_barrier
    s_add_u32 s56, s65, 555008
    buffer_load_dwordx4 v4, s[36:39], s56 offen offset:2048 lds
    s_add_u32 s56, s65, 570368
    buffer_load_dwordx4 v5, s[36:39], s56 offen offset:3072 lds
    s_add_u32 m0, s60, 49152
    s_add_u32 s56, s65, 786432
    buffer_load_dwordx4 v4, s[36:39], s56 offen lds
    s_add_u32 s56, s65, 801792
    buffer_load_dwordx4 v5, s[36:39], s56 offen offset:1024 lds
    s_add_u32 s56, s65, 817152
    buffer_load_dwordx4 v4, s[36:39], s56 offen offset:2048 lds
    s_add_u32 s56, s65, 832512
    buffer_load_dwordx4 v5, s[36:39], s56 offen offset:3072 lds
    s_add_u32 s67, s28, 1
    s_sub_u32 s57, s67, 6
    s_cselect_b32 s67, s67, s57
    s_lshl_b32 s66, s67, 7
    s_add_u32 s66, s66, s64
    s_add_u32 m0, s60, 131072
    s_add_u32 s56, s66, 128
    buffer_load_dwordx4 v6, s[32:35], s56 offen lds
    s_add_u32 s56, s66, 6272
    buffer_load_dwordx4 v7, s[32:35], s56 offen offset:1024 lds
    s_waitcnt vmcnt(6)
    s_barrier
    s_add_u32 s56, s66, 12416
    buffer_load_dwordx4 v6, s[32:35], s56 offen offset:2048 lds
    s_add_u32 s56, s66, 18560
    buffer_load_dwordx4 v7, s[32:35], s56 offen offset:3072 lds
    s_add_u32 s67, s28, 1
    s_sub_u32 s57, s67, 6
    s_cselect_b32 s67, s67, s57
    s_lshl_b32 s65, s67, 19
    s_add_u32 s65, s65, s63
    s_add_u32 m0, s60, 65536
    s_add_u32 s56, s65, 524288
    buffer_load_dwordx4 v4, s[36:39], s56 offen lds
    s_add_u32 s56, s65, 539648
    buffer_load_dwordx4 v5, s[36:39], s56 offen offset:1024 lds
    s_add_u32 s56, s65, 555008
    buffer_load_dwordx4 v4, s[36:39], s56 offen offset:2048 lds
    s_waitcnt vmcnt(7)
    s_barrier
    s_add_u32 s56, s65, 570368
    buffer_load_dwordx4 v5, s[36:39], s56 offen offset:3072 lds
    s_add_u32 m0, s60, 81920
    s_add_u32 s56, s65, 786432
    buffer_load_dwordx4 v4, s[36:39], s56 offen lds
    s_add_u32 s56, s65, 801792
    buffer_load_dwordx4 v5, s[36:39], s56 offen offset:1024 lds
    s_add_u32 s56, s65, 817152
    buffer_load_dwordx4 v4, s[36:39], s56 offen offset:2048 lds
    s_add_u32 s56, s65, 832512
    buffer_load_dwordx4 v5, s[36:39], s56 offen offset:3072 lds
    s_add_u32 s67, s28, 2
    s_sub_u32 s57, s67, 6
    s_cselect_b32 s67, s67, s57
    s_lshl_b32 s65, s67, 19
    s_add_u32 s65, s65, s63
    s_mov_b32 m0, s60
    s_add_u32 s56, s65, 524288
    buffer_load_dwordx4 v4, s[36:39], s56 offen lds
    s_add_u32 s56, s65, 539648
    buffer_load_dwordx4 v5, s[36:39], s56 offen offset:1024 lds
    s_add_u32 s56, s65, 555008
    buffer_load_dwordx4 v4, s[36:39], s56 offen offset:2048 lds
    s_add_u32 s56, s65, 570368
    buffer_load_dwordx4 v5, s[36:39], s56 offen offset:3072 lds
    s_waitcnt vmcnt(8)
    s_barrier
    s_add_u32 s67, s28, 2
    s_sub_u32 s57, s67, 6
    s_cselect_b32 s67, s67, s57
    s_lshl_b32 s66, s67, 7
    s_add_u32 s66, s66, s64
    s_add_u32 m0, s60, 98304
    s_add_u32 s56, s66, 128
    buffer_load_dwordx4 v6, s[32:35], s56 offen lds
    s_add_u32 s56, s66, 6272
    buffer_load_dwordx4 v7, s[32:35], s56 offen offset:1024 lds
    s_add_u32 s56, s66, 12416
    buffer_load_dwordx4 v6, s[32:35], s56 offen offset:2048 lds
    s_add_u32 s56, s66, 18560
    buffer_load_dwordx4 v7, s[32:35], s56 offen offset:3072 lds
    s_add_u32 m0, s60, 16384
    s_add_u32 s56, s65, 786432
    buffer_load_dwordx4 v4, s[36:39], s56 offen lds
    s_add_u32 s56, s65, 801792
    buffer_load_dwordx4 v5, s[36:39], s56 offen offset:1024 lds
    s_waitcnt vmcnt(10)
    s_barrier
    s_add_u32 s56, s65, 817152
    buffer_load_dwordx4 v4, s[36:39], s56 offen offset:2048 lds
    s_add_u32 s56, s65, 832512
    buffer_load_dwordx4 v5, s[36:39], s56 offen offset:3072 lds
    s_add_u32 s67, s28, 3
    s_sub_u32 s57, s67, 6
    s_cselect_b32 s67, s67, s57
    s_lshl_b32 s65, s67, 19
    s_add_u32 s65, s65, s63
    s_add_u32 m0, s60, 32768
    s_add_u32 s56, s65, 524288
    buffer_load_dwordx4 v4, s[36:39], s56 offen lds
    s_add_u32 s56, s65, 539648
    buffer_load_dwordx4 v5, s[36:39], s56 offen offset:1024 lds
    s_add_u32 s56, s65, 555008
    buffer_load_dwordx4 v4, s[36:39], s56 offen offset:2048 lds
    s_add_u32 s56, s65, 570368
    buffer_load_dwordx4 v5, s[36:39], s56 offen offset:3072 lds
    s_add_u32 s67, s28, 3
    s_sub_u32 s57, s67, 6
    s_cselect_b32 s67, s67, s57
    s_lshl_b32 s66, s67, 7
    s_add_u32 s66, s66, s64
    s_add_u32 m0, s60, 114688
    s_add_u32 s56, s66, 128
    buffer_load_dwordx4 v6, s[32:35], s56 offen lds
    s_add_u32 s56, s66, 6272
    buffer_load_dwordx4 v7, s[32:35], s56 offen offset:1024 lds
    s_add_u32 s56, s66, 12416
    buffer_load_dwordx4 v6, s[32:35], s56 offen offset:2048 lds
    s_waitcnt vmcnt(11)
    s_barrier
    s_add_u32 s56, s66, 18560
    buffer_load_dwordx4 v7, s[32:35], s56 offen offset:3072 lds
    s_add_u32 m0, s60, 49152
    s_add_u32 s56, s65, 786432
    buffer_load_dwordx4 v4, s[36:39], s56 offen lds
    s_add_u32 s56, s65, 801792
    buffer_load_dwordx4 v5, s[36:39], s56 offen offset:1024 lds
    s_add_u32 s56, s65, 817152
    buffer_load_dwordx4 v4, s[36:39], s56 offen offset:2048 lds
    s_add_u32 s56, s65, 832512
    buffer_load_dwordx4 v5, s[36:39], s56 offen offset:3072 lds
    s_add_u32 s67, s28, 4
    s_sub_u32 s57, s67, 6
    s_cselect_b32 s67, s67, s57
    s_lshl_b32 s65, s67, 19
    s_add_u32 s65, s65, s63
    s_add_u32 m0, s60, 65536
    s_add_u32 s56, s65, 524288
    buffer_load_dwordx4 v4, s[36:39], s56 offen lds
    s_waitcnt vmcnt(13)
    s_barrier
    s_add_u32 s56, s65, 539648
    buffer_load_dwordx4 v5, s[36:39], s56 offen offset:1024 lds
    s_add_u32 s56, s65, 555008
    buffer_load_dwordx4 v4, s[36:39], s56 offen offset:2048 lds
    s_add_u32 s56, s65, 570368
    buffer_load_dwordx4 v5, s[36:39], s56 offen offset:3072 lds
    s_add_u32 s67, s28, 4
    s_sub_u32 s57, s67, 6
    s_cselect_b32 s67, s67, s57
    s_lshl_b32 s66, s67, 7
    s_add_u32 s66, s66, s64
    s_add_u32 m0, s60, 131072
    s_add_u32 s56, s66, 128
    buffer_load_dwordx4 v6, s[32:35], s56 offen lds
    s_add_u32 s56, s66, 6272
    buffer_load_dwordx4 v7, s[32:35], s56 offen offset:1024 lds
    s_add_u32 s56, s66, 12416
    buffer_load_dwordx4 v6, s[32:35], s56 offen offset:2048 lds
    s_add_u32 s56, s66, 18560
    buffer_load_dwordx4 v7, s[32:35], s56 offen offset:3072 lds
    s_add_u32 m0, s60, 81920
    s_add_u32 s56, s65, 786432
    buffer_load_dwordx4 v4, s[36:39], s56 offen lds
    s_add_u32 s56, s65, 801792
    buffer_load_dwordx4 v5, s[36:39], s56 offen offset:1024 lds
    s_waitcnt vmcnt(14)
    s_barrier
    s_add_u32 s56, s65, 817152
    buffer_load_dwordx4 v4, s[36:39], s56 offen offset:2048 lds
    s_add_u32 s56, s65, 832512
    buffer_load_dwordx4 v5, s[36:39], s56 offen offset:3072 lds
    s_add_u32 s67, s28, 5
    s_sub_u32 s57, s67, 6
    s_cselect_b32 s67, s67, s57
    s_lshl_b32 s65, s67, 19
    s_add_u32 s65, s65, s63
    s_mov_b32 m0, s60
    s_add_u32 s56, s65, 524288
    buffer_load_dwordx4 v4, s[36:39], s56 offen lds
    s_add_u32 s56, s65, 539648
    buffer_load_dwordx4 v5, s[36:39], s56 offen offset:1024 lds
    s_add_u32 s56, s65, 555008
    buffer_load_dwordx4 v4, s[36:39], s56 offen offset:2048 lds
    s_add_u32 s56, s65, 570368
    buffer_load_dwordx4 v5, s[36:39], s56 offen offset:3072 lds
    s_waitcnt vmcnt(16)
    s_barrier
    s_add_u32 s67, s28, 5
    s_sub_u32 s57, s67, 6
    s_cselect_b32 s67, s67, s57
    s_lshl_b32 s66, s67, 7
    s_add_u32 s66, s66, s64
    s_add_u32 m0, s60, 98304
    s_add_u32 s56, s66, 128
    buffer_load_dwordx4 v6, s[32:35], s56 offen lds
    s_add_u32 s56, s66, 6272
    buffer_load_dwordx4 v7, s[32:35], s56 offen offset:1024 lds
    s_add_u32 s56, s66, 12416
    buffer_load_dwordx4 v6, s[32:35], s56 offen offset:2048 lds
    s_add_u32 s56, s66, 18560
    buffer_load_dwordx4 v7, s[32:35], s56 offen offset:3072 lds
    s_add_u32 m0, s60, 16384
    s_add_u32 s56, s65, 786432
    buffer_load_dwordx4 v4, s[36:39], s56 offen lds
    s_add_u32 s56, s65, 801792
    buffer_load_dwordx4 v5, s[36:39], s56 offen offset:1024 lds
    s_add_u32 s56, s65, 817152
    buffer_load_dwordx4 v4, s[36:39], s56 offen offset:2048 lds
    s_add_u32 s56, s65, 832512
    buffer_load_dwordx4 v5, s[36:39], s56 offen offset:3072 lds
    s_waitcnt vmcnt(16)
    s_barrier
    s_add_u32 m0, s60, 147456
    s_nop 0
    buffer_load_dwordx4 v8, s[40:43], s62 offen lds
    s_add_u32 s56, s62, 3072
    buffer_load_dwordx4 v9, s[40:43], s56 offen offset:1024 lds
    s_add_u32 s56, s62, 6144
    buffer_load_dwordx4 v8, s[40:43], s56 offen offset:2048 lds
    s_add_u32 s56, s62, 9216
    buffer_load_dwordx4 v9, s[40:43], s56 offen offset:3072 lds
    s_waitcnt vmcnt(4)
    s_barrier
    s_add_u32 m0, s60, 32768
    s_add_u32 s56, s62, 128
    buffer_load_dwordx4 v8, s[40:43], s56 offen lds
    s_add_u32 s56, s62, 3200
    buffer_load_dwordx4 v9, s[40:43], s56 offen offset:1024 lds
    s_add_u32 s56, s62, 6272
    buffer_load_dwordx4 v8, s[40:43], s56 offen offset:2048 lds
    s_add_u32 s56, s62, 9344
    buffer_load_dwordx4 v9, s[40:43], s56 offen offset:3072 lds
    s_add_u32 m0, s60, 49152
    s_add_u32 s56, s62, 256
    buffer_load_dwordx4 v8, s[40:43], s56 offen lds
    s_add_u32 s56, s62, 3328
    buffer_load_dwordx4 v9, s[40:43], s56 offen offset:1024 lds
    s_add_u32 s56, s62, 6400
    buffer_load_dwordx4 v8, s[40:43], s56 offen offset:2048 lds
    s_add_u32 s56, s62, 9472
    buffer_load_dwordx4 v9, s[40:43], s56 offen offset:3072 lds
    s_add_u32 m0, s60, 114688
    s_add_u32 s56, s62, 384
    buffer_load_dwordx4 v8, s[40:43], s56 offen lds
    s_add_u32 s56, s62, 3456
    buffer_load_dwordx4 v9, s[40:43], s56 offen offset:1024 lds
    s_add_u32 s56, s62, 6528
    buffer_load_dwordx4 v8, s[40:43], s56 offen offset:2048 lds
    s_add_u32 s56, s62, 9600
    buffer_load_dwordx4 v9, s[40:43], s56 offen offset:3072 lds
    s_waitcnt vmcnt(8)
    s_barrier
    s_waitcnt vmcnt(4)
    s_barrier
    s_waitcnt vmcnt(0)
    s_barrier
    s_barrier
    s_endpgm
.fill (2800 - (. - L_Srest)) / 4, 4, 0xbf800000
L_Scomp:
    v_lshrrev_b32 v2, 4, v1
    v_bfe_u32 v3, v1, 2, 2
    v_and_b32 v4, 3, v1
    v_bfe_u32 v5, v1, 4, 1
    v_lshl_or_b32 v5, v5, 2, v3
    s_and_b32 s56, s26, 1
    s_lshl_b32 s57, s56, 1
    v_xor_b32 v5, s57, v5
    v_lshlrev_b32 v5, 5, v5
    v_lshl_add_u32 v5, v4, 3, v5
    v_lshl_add_u32 v6, v2, 3, v3
    v_lshl_add_u32 v192, v6, 9, v5
    v_xor_b32 v193, 32, v192
    v_xor_b32 v194, 128, v192
    v_xor_b32 v195, 160, v192
    v_add_u32 v196, 0x10000, v192
    v_add_u32 v197, 0x10000, v193
    v_add_u32 v198, 0x10000, v194
    v_add_u32 v199, 0x10000, v195
    v_and_b32 v5, 15, v1
    v_bfe_u32 v6, v1, 1, 3
    v_xor_b32 v7, v6, v2
    v_lshlrev_b32 v7, 4, v7
    v_lshl_add_u32 v7, v5, 7, v7
    s_add_u32 s57, s60, 98304
    v_add_u32 v201, s57, v7
    v_xor_b32 v200, 0x1000, v201
    v_xor_b32 v202, 64, v200
    v_xor_b32 v203, 64, v201
    v_lshrrev_b32 v7, 5, v1
    s_lshl_b32 s57, s56, 2
    v_or_b32 v7, s57, v7
    v_xor_b32 v7, v7, v6
    v_lshlrev_b32 v7, 4, v7
    v_bfe_u32 v6, v1, 4, 1
    v_lshl_add_u32 v7, v6, 3, v7
    v_lshl_add_u32 v7, v5, 7, v7
    s_add_u32 s57, s60, 32768
    v_add_u32 v206, s57, v7
    v_xor_b32 v204, 0x1000, v206
    v_xor_b32 v205, 32, v204
    v_xor_b32 v207, 32, v206
    v_add_u32 v208, 81920, v204
    v_add_u32 v209, 81920, v205
    v_add_u32 v210, 81920, v206
    v_add_u32 v211, 81920, v207
    v_mov_b32 v213, 0
    v_lshlrev_b32 v214, 4, v1
    v_add_u32 v216, s60, v214
    v_xor_b32 v217, 0x1000, v216
    s_and_b32 s56, s2, 7
    s_and_b32 s57, s22, 1
    s_lshl_b32 s27, s56, 1
    s_add_u32 s27, s27, s57
    s_bfe_u32 s24, s22, 0x30001
    s_lshl_b32 s63, s24, 2
    s_add_u32 s63, s63, s26
    s_lshl_b32 s63, s63, 4
    s_add_u32 s63, s63, s27
    s_lshl_b32 s66, s63, 7
    s_add_u32 s66, s66, 6291456
    s_lshl_b32 s63, s63, 11
    s_mov_b32 s64, 0x3db8aa3b
    s_mov_b32 s65, 0x3db8aa3b
    s_waitcnt lgkmcnt(0)
    s_mov_b32 s44, s18
    s_and_b32 s45, s19, 0xffff
    s_mov_b32 s46, 268435456
    s_mov_b32 s47, 0x20000
    s_mov_b32 s48, s16
    s_and_b32 s49, s17, 0xffff
    s_mov_b32 s50, 256
    s_mov_b32 s51, 0x20000
    s_xor_b32 s56, s26, 1
    s_or_b32 s56, s56, s2
    s_cbranch_scc1 L_noep
    s_memrealtime s[58:59]
    s_waitcnt lgkmcnt(0)
    s_or_b32 s58, s58, 1
    v_mov_b32 v212, s58
    buffer_store_dword v212, v213, s[48:51], 0 offen sc1
L_noep:
    s_mov_b32 s40, 0x3fff3fff
    v_and_b32 v215, 1, v1
    s_barrier
    ds_read_b128 v[160:163], v200
    ds_read_b128 v[164:167], v200 offset:2048
    ds_read_b128 v[168:171], v201
    ds_read_b128 v[172:175], v201 offset:2048
    ds_read_b64_tr_b16 v[128:129], v192
    ds_read_b64_tr_b16 v[130:131], v192 offset:2048
    ds_read_b64_tr_b16 v[132:133], v193
    ds_read_b64_tr_b16 v[134:135], v193 offset:2048
    ds_read_b64_tr_b16 v[136:137], v194
    ds_read_b64_tr_b16 v[138:139], v194 offset:2048
    ds_read_b64_tr_b16 v[140:141], v195
    ds_read_b64_tr_b16 v[142:143], v195 offset:2048
    ds_read_b64_tr_b16 v[144:145], v192 offset:256
    ds_read_b64_tr_b16 v[146:147], v192 offset:2304
    ds_read_b64_tr_b16 v[148:149], v193 offset:256
    ds_read_b64_tr_b16 v[150:151], v193 offset:2304
    ds_read_b64_tr_b16 v[152:153], v194 offset:256
    ds_read_b64_tr_b16 v[154:155], v194 offset:2304
    ds_read_b64_tr_b16 v[156:157], v195 offset:256
    ds_read_b64_tr_b16 v[158:159], v195 offset:2304
    s_waitcnt lgkmcnt(14)
    v_mfma_f32_16x16x32_bf16 v[0:3], v[128:131], v[160:163], 0
    s_barrier
    v_mfma_f32_16x16x32_bf16 v[8:11], v[128:131], v[164:167], 0
    ds_read_b128 v[176:179], v202
    v_mfma_f32_16x16x32_bf16 v[16:19], v[128:131], v[168:171], 0
    v_mfma_f32_16x16x32_bf16 v[24:27], v[128:131], v[172:175], 0
    ds_read_b64_tr_b16 v[128:129], v192 offset:16384
    s_waitcnt lgkmcnt(13)
    v_mfma_f32_16x16x32_bf16 v[4:7], v[132:135], v[160:163], 0
    ds_read_b64_tr_b16 v[130:131], v192 offset:18432
    v_mfma_f32_16x16x32_bf16 v[12:15], v[132:135], v[164:167], 0
    ds_read_b128 v[180:183], v202 offset:2048
    v_mfma_f32_16x16x32_bf16 v[20:23], v[132:135], v[168:171], 0
    v_mfma_f32_16x16x32_bf16 v[28:31], v[132:135], v[172:175], 0
    ds_read_b64_tr_b16 v[132:133], v193 offset:16384
    s_waitcnt lgkmcnt(8)
    v_mfma_f32_16x16x32_bf16 v[32:35], v[136:139], v[160:163], 0
    ds_read_b64_tr_b16 v[134:135], v193 offset:18432
    v_mfma_f32_16x16x32_bf16 v[40:43], v[136:139], v[164:167], 0
    ds_read_b128 v[184:187], v203
    v_mfma_f32_16x16x32_bf16 v[48:51], v[136:139], v[168:171], 0
    v_mfma_f32_16x16x32_bf16 v[56:59], v[136:139], v[172:175], 0
    ds_read_b64_tr_b16 v[136:137], v194 offset:16384
    v_mfma_f32_16x16x32_bf16 v[36:39], v[140:143], v[160:163], 0
    ds_read_b64_tr_b16 v[138:139], v194 offset:18432
    v_mfma_f32_16x16x32_bf16 v[44:47], v[140:143], v[164:167], 0
    ds_read_b128 v[188:191], v203 offset:2048
    v_mfma_f32_16x16x32_bf16 v[52:55], v[140:143], v[168:171], 0
    v_mfma_f32_16x16x32_bf16 v[60:63], v[140:143], v[172:175], 0
    ds_read_b64_tr_b16 v[140:141], v195 offset:16384
    v_mfma_f32_16x16x32_bf16 v[64:67], v[144:147], v[160:163], 0
    ds_read_b64_tr_b16 v[142:143], v195 offset:18432
    v_mfma_f32_16x16x32_bf16 v[72:75], v[144:147], v[164:167], 0
    v_mfma_f32_16x16x32_bf16 v[80:83], v[144:147], v[168:171], 0
    v_mfma_f32_16x16x32_bf16 v[88:91], v[144:147], v[172:175], 0
    ds_read_b64_tr_b16 v[144:145], v192 offset:16640
    v_mfma_f32_16x16x32_bf16 v[68:71], v[148:151], v[160:163], 0
    ds_read_b64_tr_b16 v[146:147], v192 offset:18688
    v_mfma_f32_16x16x32_bf16 v[76:79], v[148:151], v[164:167], 0
    v_mfma_f32_16x16x32_bf16 v[84:87], v[148:151], v[168:171], 0
    v_mfma_f32_16x16x32_bf16 v[92:95], v[148:151], v[172:175], 0
    ds_read_b64_tr_b16 v[148:149], v193 offset:16640
    s_waitcnt lgkmcnt(7)
    v_mfma_f32_16x16x32_bf16 v[96:99], v[152:155], v[160:163], 0
    ds_read_b64_tr_b16 v[150:151], v193 offset:18688
    v_mfma_f32_16x16x32_bf16 v[104:107], v[152:155], v[164:167], 0
    v_mfma_f32_16x16x32_bf16 v[112:115], v[152:155], v[168:171], 0
    v_mfma_f32_16x16x32_bf16 v[120:123], v[152:155], v[172:175], 0
    ds_read_b64_tr_b16 v[152:153], v194 offset:16640
    v_mfma_f32_16x16x32_bf16 v[100:103], v[156:159], v[160:163], 0
    ds_read_b64_tr_b16 v[154:155], v194 offset:18688
    v_mfma_f32_16x16x32_bf16 v[108:111], v[156:159], v[164:167], 0
    v_mfma_f32_16x16x32_bf16 v[116:119], v[156:159], v[168:171], 0
    v_mfma_f32_16x16x32_bf16 v[124:127], v[156:159], v[172:175], 0
    ds_read_b64_tr_b16 v[156:157], v195 offset:16640
    v_mfma_f32_16x16x32_bf16 v[0:3], v[128:131], v[176:179], v[0:3]
    ds_read_b64_tr_b16 v[158:159], v195 offset:18688
    s_barrier
    v_mfma_f32_16x16x32_bf16 v[8:11], v[128:131], v[180:183], v[8:11]
    ds_read_b128 v[160:163], v200 offset:16384
    v_mfma_f32_16x16x32_bf16 v[16:19], v[128:131], v[184:187], v[16:19]
    s_waitcnt lgkmcnt(6)
    v_mfma_f32_16x16x32_bf16 v[24:27], v[128:131], v[188:191], v[24:27]
    ds_read_b64_tr_b16 v[128:129], v192 offset:32768
    v_mfma_f32_16x16x32_bf16 v[4:7], v[132:135], v[176:179], v[4:7]
    ds_read_b64_tr_b16 v[130:131], v192 offset:34816
    v_mfma_f32_16x16x32_bf16 v[12:15], v[132:135], v[180:183], v[12:15]
    ds_read_b128 v[164:167], v200 offset:18432
    v_mfma_f32_16x16x32_bf16 v[20:23], v[132:135], v[184:187], v[20:23]
    v_mfma_f32_16x16x32_bf16 v[28:31], v[132:135], v[188:191], v[28:31]
    ds_read_b64_tr_b16 v[132:133], v193 offset:32768
    v_mfma_f32_16x16x32_bf16 v[32:35], v[136:139], v[176:179], v[32:35]
    ds_read_b64_tr_b16 v[134:135], v193 offset:34816
    v_mfma_f32_16x16x32_bf16 v[40:43], v[136:139], v[180:183], v[40:43]
    ds_read_b128 v[168:171], v201 offset:16384
    v_mfma_f32_16x16x32_bf16 v[48:51], v[136:139], v[184:187], v[48:51]
    v_mfma_f32_16x16x32_bf16 v[56:59], v[136:139], v[188:191], v[56:59]
    ds_read_b64_tr_b16 v[136:137], v194 offset:32768
    v_mfma_f32_16x16x32_bf16 v[36:39], v[140:143], v[176:179], v[36:39]
    ds_read_b64_tr_b16 v[138:139], v194 offset:34816
    v_mfma_f32_16x16x32_bf16 v[44:47], v[140:143], v[180:183], v[44:47]
    ds_read_b128 v[172:175], v201 offset:18432
    v_mfma_f32_16x16x32_bf16 v[52:55], v[140:143], v[184:187], v[52:55]
    v_mfma_f32_16x16x32_bf16 v[60:63], v[140:143], v[188:191], v[60:63]
    ds_read_b64_tr_b16 v[140:141], v195 offset:32768
    v_mfma_f32_16x16x32_bf16 v[64:67], v[144:147], v[176:179], v[64:67]
    ds_read_b64_tr_b16 v[142:143], v195 offset:34816
    v_mfma_f32_16x16x32_bf16 v[72:75], v[144:147], v[180:183], v[72:75]
    v_mfma_f32_16x16x32_bf16 v[80:83], v[144:147], v[184:187], v[80:83]
    v_mfma_f32_16x16x32_bf16 v[88:91], v[144:147], v[188:191], v[88:91]
    ds_read_b64_tr_b16 v[144:145], v192 offset:33024
    s_waitcnt lgkmcnt(8)
    v_mfma_f32_16x16x32_bf16 v[68:71], v[148:151], v[176:179], v[68:71]
    ds_read_b64_tr_b16 v[146:147], v192 offset:35072
    v_mfma_f32_16x16x32_bf16 v[76:79], v[148:151], v[180:183], v[76:79]
    v_mfma_f32_16x16x32_bf16 v[84:87], v[148:151], v[184:187], v[84:87]
    v_mfma_f32_16x16x32_bf16 v[92:95], v[148:151], v[188:191], v[92:95]
    ds_read_b64_tr_b16 v[148:149], v193 offset:33024
    v_mfma_f32_16x16x32_bf16 v[96:99], v[152:155], v[176:179], v[96:99]
    ds_read_b64_tr_b16 v[150:151], v193 offset:35072
    v_mfma_f32_16x16x32_bf16 v[104:107], v[152:155], v[180:183], v[104:107]
    v_mfma_f32_16x16x32_bf16 v[112:115], v[152:155], v[184:187], v[112:115]
    v_mfma_f32_16x16x32_bf16 v[120:123], v[152:155], v[188:191], v[120:123]
    ds_read_b64_tr_b16 v[152:153], v194 offset:33024
    v_mfma_f32_16x16x32_bf16 v[100:103], v[156:159], v[176:179], v[100:103]
    ds_read_b64_tr_b16 v[154:155], v194 offset:35072
    v_mfma_f32_16x16x32_bf16 v[108:111], v[156:159], v[180:183], v[108:111]
    v_mfma_f32_16x16x32_bf16 v[116:119], v[156:159], v[184:187], v[116:119]
    v_mfma_f32_16x16x32_bf16 v[124:127], v[156:159], v[188:191], v[124:127]
    ds_read_b64_tr_b16 v[156:157], v195 offset:33024
    v_mfma_f32_16x16x32_bf16 v[0:3], v[128:131], v[160:163], v[0:3]
    ds_read_b64_tr_b16 v[158:159], v195 offset:35072
    s_barrier
    buffer_load_dword v212, v213, s[48:51], 0 offen sc1
    v_mfma_f32_16x16x32_bf16 v[8:11], v[128:131], v[164:167], v[8:11]
    ds_read_b128 v[176:179], v202 offset:16384
    s_waitcnt lgkmcnt(7)
    v_mfma_f32_16x16x32_bf16 v[16:19], v[128:131], v[168:171], v[16:19]
    v_mfma_f32_16x16x32_bf16 v[24:27], v[128:131], v[172:175], v[24:27]
    ds_read_b64_tr_b16 v[128:129], v192 offset:49152
    v_mfma_f32_16x16x32_bf16 v[4:7], v[132:135], v[160:163], v[4:7]
    ds_read_b64_tr_b16 v[130:131], v192 offset:51200
    v_mfma_f32_16x16x32_bf16 v[12:15], v[132:135], v[164:167], v[12:15]
    ds_read_b128 v[180:183], v202 offset:18432
    v_mfma_f32_16x16x32_bf16 v[20:23], v[132:135], v[168:171], v[20:23]
    v_mfma_f32_16x16x32_bf16 v[28:31], v[132:135], v[172:175], v[28:31]
    ds_read_b64_tr_b16 v[132:133], v193 offset:49152
    v_mfma_f32_16x16x32_bf16 v[32:35], v[136:139], v[160:163], v[32:35]
    ds_read_b64_tr_b16 v[134:135], v193 offset:51200
    v_mfma_f32_16x16x32_bf16 v[40:43], v[136:139], v[164:167], v[40:43]
    ds_read_b128 v[184:187], v203 offset:16384
    v_mfma_f32_16x16x32_bf16 v[48:51], v[136:139], v[168:171], v[48:51]
    v_mfma_f32_16x16x32_bf16 v[56:59], v[136:139], v[172:175], v[56:59]
    ds_read_b64_tr_b16 v[136:137], v194 offset:49152
    v_mfma_f32_16x16x32_bf16 v[36:39], v[140:143], v[160:163], v[36:39]
    ds_read_b64_tr_b16 v[138:139], v194 offset:51200
    v_mfma_f32_16x16x32_bf16 v[44:47], v[140:143], v[164:167], v[44:47]
    ds_read_b128 v[188:191], v203 offset:18432
    v_mfma_f32_16x16x32_bf16 v[52:55], v[140:143], v[168:171], v[52:55]
    v_mfma_f32_16x16x32_bf16 v[60:63], v[140:143], v[172:175], v[60:63]
    ds_read_b64_tr_b16 v[140:141], v195 offset:49152
    v_mfma_f32_16x16x32_bf16 v[64:67], v[144:147], v[160:163], v[64:67]
    ds_read_b64_tr_b16 v[142:143], v195 offset:51200
    v_mfma_f32_16x16x32_bf16 v[72:75], v[144:147], v[164:167], v[72:75]
    v_mfma_f32_16x16x32_bf16 v[80:83], v[144:147], v[168:171], v[80:83]
    v_mfma_f32_16x16x32_bf16 v[88:91], v[144:147], v[172:175], v[88:91]
    ds_read_b64_tr_b16 v[144:145], v192 offset:49408
    s_waitcnt lgkmcnt(8)
    v_mfma_f32_16x16x32_bf16 v[68:71], v[148:151], v[160:163], v[68:71]
    ds_read_b64_tr_b16 v[146:147], v192 offset:51456
    v_mfma_f32_16x16x32_bf16 v[76:79], v[148:151], v[164:167], v[76:79]
    v_mfma_f32_16x16x32_bf16 v[84:87], v[148:151], v[168:171], v[84:87]
    v_mfma_f32_16x16x32_bf16 v[92:95], v[148:151], v[172:175], v[92:95]
    ds_read_b64_tr_b16 v[148:149], v193 offset:49408
    v_mfma_f32_16x16x32_bf16 v[96:99], v[152:155], v[160:163], v[96:99]
    ds_read_b64_tr_b16 v[150:151], v193 offset:51456
    v_mfma_f32_16x16x32_bf16 v[104:107], v[152:155], v[164:167], v[104:107]
    v_mfma_f32_16x16x32_bf16 v[112:115], v[152:155], v[168:171], v[112:115]
    v_mfma_f32_16x16x32_bf16 v[120:123], v[152:155], v[172:175], v[120:123]
    ds_read_b64_tr_b16 v[152:153], v194 offset:49408
    v_mfma_f32_16x16x32_bf16 v[100:103], v[156:159], v[160:163], v[100:103]
    ds_read_b64_tr_b16 v[154:155], v194 offset:51456
    v_mfma_f32_16x16x32_bf16 v[108:111], v[156:159], v[164:167], v[108:111]
    v_mfma_f32_16x16x32_bf16 v[116:119], v[156:159], v[168:171], v[116:119]
    v_mfma_f32_16x16x32_bf16 v[124:127], v[156:159], v[172:175], v[124:127]
    ds_read_b64_tr_b16 v[156:157], v195 offset:49408
    v_mfma_f32_16x16x32_bf16 v[0:3], v[128:131], v[176:179], v[0:3]
    ds_read_b64_tr_b16 v[158:159], v195 offset:51456
    s_barrier
    v_mfma_f32_16x16x32_bf16 v[8:11], v[128:131], v[180:183], v[8:11]
    ds_read_b128 v[160:163], v200 offset:32768
    s_waitcnt lgkmcnt(7)
    v_mfma_f32_16x16x32_bf16 v[16:19], v[128:131], v[184:187], v[16:19]
    v_mfma_f32_16x16x32_bf16 v[24:27], v[128:131], v[188:191], v[24:27]
    ds_read_b64_tr_b16 v[128:129], v196
    v_mfma_f32_16x16x32_bf16 v[4:7], v[132:135], v[176:179], v[4:7]
    ds_read_b64_tr_b16 v[130:131], v196 offset:2048
    v_mfma_f32_16x16x32_bf16 v[12:15], v[132:135], v[180:183], v[12:15]
    ds_read_b128 v[164:167], v200 offset:34816
    v_mfma_f32_16x16x32_bf16 v[20:23], v[132:135], v[184:187], v[20:23]
    v_mfma_f32_16x16x32_bf16 v[28:31], v[132:135], v[188:191], v[28:31]
    ds_read_b64_tr_b16 v[132:133], v197
    v_mfma_f32_16x16x32_bf16 v[32:35], v[136:139], v[176:179], v[32:35]
    ds_read_b64_tr_b16 v[134:135], v197 offset:2048
    v_mfma_f32_16x16x32_bf16 v[40:43], v[136:139], v[180:183], v[40:43]
    ds_read_b128 v[168:171], v201 offset:32768
    v_mfma_f32_16x16x32_bf16 v[48:51], v[136:139], v[184:187], v[48:51]
    v_mfma_f32_16x16x32_bf16 v[56:59], v[136:139], v[188:191], v[56:59]
    ds_read_b64_tr_b16 v[136:137], v198
    v_mfma_f32_16x16x32_bf16 v[36:39], v[140:143], v[176:179], v[36:39]
    ds_read_b64_tr_b16 v[138:139], v198 offset:2048
    v_mfma_f32_16x16x32_bf16 v[44:47], v[140:143], v[180:183], v[44:47]
    ds_read_b128 v[172:175], v201 offset:34816
    v_mfma_f32_16x16x32_bf16 v[52:55], v[140:143], v[184:187], v[52:55]
    v_mfma_f32_16x16x32_bf16 v[60:63], v[140:143], v[188:191], v[60:63]
    ds_read_b64_tr_b16 v[140:141], v199
    v_mfma_f32_16x16x32_bf16 v[64:67], v[144:147], v[176:179], v[64:67]
    ds_read_b64_tr_b16 v[142:143], v199 offset:2048
    v_mfma_f32_16x16x32_bf16 v[72:75], v[144:147], v[180:183], v[72:75]
    v_mfma_f32_16x16x32_bf16 v[80:83], v[144:147], v[184:187], v[80:83]
    v_mfma_f32_16x16x32_bf16 v[88:91], v[144:147], v[188:191], v[88:91]
    ds_read_b64_tr_b16 v[144:145], v196 offset:256
    s_waitcnt lgkmcnt(8)
    v_mfma_f32_16x16x32_bf16 v[68:71], v[148:151], v[176:179], v[68:71]
    ds_read_b64_tr_b16 v[146:147], v196 offset:2304
    v_mfma_f32_16x16x32_bf16 v[76:79], v[148:151], v[180:183], v[76:79]
    v_mfma_f32_16x16x32_bf16 v[84:87], v[148:151], v[184:187], v[84:87]
    v_mfma_f32_16x16x32_bf16 v[92:95], v[148:151], v[188:191], v[92:95]
    ds_read_b64_tr_b16 v[148:149], v197 offset:256
    v_mfma_f32_16x16x32_bf16 v[96:99], v[152:155], v[176:179], v[96:99]
    ds_read_b64_tr_b16 v[150:151], v197 offset:2304
    v_mfma_f32_16x16x32_bf16 v[104:107], v[152:155], v[180:183], v[104:107]
    v_mfma_f32_16x16x32_bf16 v[112:115], v[152:155], v[184:187], v[112:115]
    v_mfma_f32_16x16x32_bf16 v[120:123], v[152:155], v[188:191], v[120:123]
    ds_read_b64_tr_b16 v[152:153], v198 offset:256
    v_mfma_f32_16x16x32_bf16 v[100:103], v[156:159], v[176:179], v[100:103]
    ds_read_b64_tr_b16 v[154:155], v198 offset:2304
    v_mfma_f32_16x16x32_bf16 v[108:111], v[156:159], v[180:183], v[108:111]
    v_mfma_f32_16x16x32_bf16 v[116:119], v[156:159], v[184:187], v[116:119]
    v_mfma_f32_16x16x32_bf16 v[124:127], v[156:159], v[188:191], v[124:127]
    ds_read_b64_tr_b16 v[156:157], v199 offset:256
    v_mfma_f32_16x16x32_bf16 v[0:3], v[128:131], v[160:163], v[0:3]
    ds_read_b64_tr_b16 v[158:159], v199 offset:2304
    s_barrier
    v_mfma_f32_16x16x32_bf16 v[8:11], v[128:131], v[164:167], v[8:11]
    ds_read_b128 v[176:179], v202 offset:32768
    s_waitcnt lgkmcnt(7)
    v_mfma_f32_16x16x32_bf16 v[16:19], v[128:131], v[168:171], v[16:19]
    v_mfma_f32_16x16x32_bf16 v[24:27], v[128:131], v[172:175], v[24:27]
    ds_read_b64_tr_b16 v[128:129], v196 offset:16384
    v_mfma_f32_16x16x32_bf16 v[4:7], v[132:135], v[160:163], v[4:7]
    ds_read_b64_tr_b16 v[130:131], v196 offset:18432
    v_mfma_f32_16x16x32_bf16 v[12:15], v[132:135], v[164:167], v[12:15]
    ds_read_b128 v[180:183], v202 offset:34816
    v_mfma_f32_16x16x32_bf16 v[20:23], v[132:135], v[168:171], v[20:23]
    v_mfma_f32_16x16x32_bf16 v[28:31], v[132:135], v[172:175], v[28:31]
    ds_read_b64_tr_b16 v[132:133], v197 offset:16384
    v_mfma_f32_16x16x32_bf16 v[32:35], v[136:139], v[160:163], v[32:35]
    ds_read_b64_tr_b16 v[134:135], v197 offset:18432
    v_mfma_f32_16x16x32_bf16 v[40:43], v[136:139], v[164:167], v[40:43]
    ds_read_b128 v[184:187], v203 offset:32768
    v_mfma_f32_16x16x32_bf16 v[48:51], v[136:139], v[168:171], v[48:51]
    v_mfma_f32_16x16x32_bf16 v[56:59], v[136:139], v[172:175], v[56:59]
    ds_read_b64_tr_b16 v[136:137], v198 offset:16384
    v_mfma_f32_16x16x32_bf16 v[36:39], v[140:143], v[160:163], v[36:39]
    ds_read_b64_tr_b16 v[138:139], v198 offset:18432
    v_mfma_f32_16x16x32_bf16 v[44:47], v[140:143], v[164:167], v[44:47]
    ds_read_b128 v[188:191], v203 offset:34816
    v_mfma_f32_16x16x32_bf16 v[52:55], v[140:143], v[168:171], v[52:55]
    v_mfma_f32_16x16x32_bf16 v[60:63], v[140:143], v[172:175], v[60:63]
    ds_read_b64_tr_b16 v[140:141], v199 offset:16384
    v_mfma_f32_16x16x32_bf16 v[64:67], v[144:147], v[160:163], v[64:67]
    ds_read_b64_tr_b16 v[142:143], v199 offset:18432
    v_mfma_f32_16x16x32_bf16 v[72:75], v[144:147], v[164:167], v[72:75]
    v_mfma_f32_16x16x32_bf16 v[80:83], v[144:147], v[168:171], v[80:83]
    v_mfma_f32_16x16x32_bf16 v[88:91], v[144:147], v[172:175], v[88:91]
    ds_read_b64_tr_b16 v[144:145], v196 offset:16640
    s_waitcnt lgkmcnt(8)
    v_mfma_f32_16x16x32_bf16 v[68:71], v[148:151], v[160:163], v[68:71]
    ds_read_b64_tr_b16 v[146:147], v196 offset:18688
    v_mfma_f32_16x16x32_bf16 v[76:79], v[148:151], v[164:167], v[76:79]
    v_mfma_f32_16x16x32_bf16 v[84:87], v[148:151], v[168:171], v[84:87]
    v_mfma_f32_16x16x32_bf16 v[92:95], v[148:151], v[172:175], v[92:95]
    ds_read_b64_tr_b16 v[148:149], v197 offset:16640
    v_mfma_f32_16x16x32_bf16 v[96:99], v[152:155], v[160:163], v[96:99]
    ds_read_b64_tr_b16 v[150:151], v197 offset:18688
    v_mfma_f32_16x16x32_bf16 v[104:107], v[152:155], v[164:167], v[104:107]
    v_mfma_f32_16x16x32_bf16 v[112:115], v[152:155], v[168:171], v[112:115]
    v_mfma_f32_16x16x32_bf16 v[120:123], v[152:155], v[172:175], v[120:123]
    ds_read_b64_tr_b16 v[152:153], v198 offset:16640
    v_mfma_f32_16x16x32_bf16 v[100:103], v[156:159], v[160:163], v[100:103]
    ds_read_b64_tr_b16 v[154:155], v198 offset:18688
    v_mfma_f32_16x16x32_bf16 v[108:111], v[156:159], v[164:167], v[108:111]
    v_mfma_f32_16x16x32_bf16 v[116:119], v[156:159], v[168:171], v[116:119]
    v_mfma_f32_16x16x32_bf16 v[124:127], v[156:159], v[172:175], v[124:127]
    ds_read_b64_tr_b16 v[156:157], v199 offset:16640
    v_mfma_f32_16x16x32_bf16 v[0:3], v[128:131], v[176:179], v[0:3]
    ds_read_b64_tr_b16 v[158:159], v199 offset:18688
    s_barrier
    v_mfma_f32_16x16x32_bf16 v[8:11], v[128:131], v[180:183], v[8:11]
    ds_read_b128 v[160:163], v200
    s_waitcnt lgkmcnt(7)
    v_mfma_f32_16x16x32_bf16 v[16:19], v[128:131], v[184:187], v[16:19]
    v_mfma_f32_16x16x32_bf16 v[24:27], v[128:131], v[188:191], v[24:27]
    ds_read_b64_tr_b16 v[128:129], v192
    v_mfma_f32_16x16x32_bf16 v[4:7], v[132:135], v[176:179], v[4:7]
    ds_read_b64_tr_b16 v[130:131], v192 offset:2048
    v_mfma_f32_16x16x32_bf16 v[12:15], v[132:135], v[180:183], v[12:15]
    ds_read_b128 v[164:167], v200 offset:2048
    v_mfma_f32_16x16x32_bf16 v[20:23], v[132:135], v[184:187], v[20:23]
    v_mfma_f32_16x16x32_bf16 v[28:31], v[132:135], v[188:191], v[28:31]
    ds_read_b64_tr_b16 v[132:133], v193
    v_mfma_f32_16x16x32_bf16 v[32:35], v[136:139], v[176:179], v[32:35]
    ds_read_b64_tr_b16 v[134:135], v193 offset:2048
    v_mfma_f32_16x16x32_bf16 v[40:43], v[136:139], v[180:183], v[40:43]
    ds_read_b128 v[168:171], v201
    v_mfma_f32_16x16x32_bf16 v[48:51], v[136:139], v[184:187], v[48:51]
    v_mfma_f32_16x16x32_bf16 v[56:59], v[136:139], v[188:191], v[56:59]
    ds_read_b64_tr_b16 v[136:137], v194
    v_mfma_f32_16x16x32_bf16 v[36:39], v[140:143], v[176:179], v[36:39]
    ds_read_b64_tr_b16 v[138:139], v194 offset:2048
    v_mfma_f32_16x16x32_bf16 v[44:47], v[140:143], v[180:183], v[44:47]
    ds_read_b128 v[172:175], v201 offset:2048
    v_mfma_f32_16x16x32_bf16 v[52:55], v[140:143], v[184:187], v[52:55]
    v_mfma_f32_16x16x32_bf16 v[60:63], v[140:143], v[188:191], v[60:63]
    ds_read_b64_tr_b16 v[140:141], v195
    v_mfma_f32_16x16x32_bf16 v[64:67], v[144:147], v[176:179], v[64:67]
    ds_read_b64_tr_b16 v[142:143], v195 offset:2048
    v_mfma_f32_16x16x32_bf16 v[72:75], v[144:147], v[180:183], v[72:75]
    v_mfma_f32_16x16x32_bf16 v[80:83], v[144:147], v[184:187], v[80:83]
    v_mfma_f32_16x16x32_bf16 v[88:91], v[144:147], v[188:191], v[88:91]
    ds_read_b64_tr_b16 v[144:145], v192 offset:256
    s_waitcnt lgkmcnt(8)
    v_mfma_f32_16x16x32_bf16 v[68:71], v[148:151], v[176:179], v[68:71]
    ds_read_b64_tr_b16 v[146:147], v192 offset:2304
    v_mfma_f32_16x16x32_bf16 v[76:79], v[148:151], v[180:183], v[76:79]
    v_mfma_f32_16x16x32_bf16 v[84:87], v[148:151], v[184:187], v[84:87]
    v_mfma_f32_16x16x32_bf16 v[92:95], v[148:151], v[188:191], v[92:95]
    ds_read_b64_tr_b16 v[148:149], v193 offset:256
    v_mfma_f32_16x16x32_bf16 v[96:99], v[152:155], v[176:179], v[96:99]
    ds_read_b64_tr_b16 v[150:151], v193 offset:2304
    v_mfma_f32_16x16x32_bf16 v[104:107], v[152:155], v[180:183], v[104:107]
    v_mfma_f32_16x16x32_bf16 v[112:115], v[152:155], v[184:187], v[112:115]
    v_mfma_f32_16x16x32_bf16 v[120:123], v[152:155], v[188:191], v[120:123]
    ds_read_b64_tr_b16 v[152:153], v194 offset:256
    v_mfma_f32_16x16x32_bf16 v[100:103], v[156:159], v[176:179], v[100:103]
    ds_read_b64_tr_b16 v[154:155], v194 offset:2304
    v_mfma_f32_16x16x32_bf16 v[108:111], v[156:159], v[180:183], v[108:111]
    v_mfma_f32_16x16x32_bf16 v[116:119], v[156:159], v[184:187], v[116:119]
    v_mfma_f32_16x16x32_bf16 v[124:127], v[156:159], v[188:191], v[124:127]
    ds_read_b64_tr_b16 v[156:157], v195 offset:256
    v_mfma_f32_16x16x32_bf16 v[0:3], v[128:131], v[160:163], v[0:3]
    ds_read_b64_tr_b16 v[158:159], v195 offset:2304
    s_barrier
    v_mfma_f32_16x16x32_bf16 v[8:11], v[128:131], v[164:167], v[8:11]
    ds_read_b128 v[176:179], v202
    s_waitcnt lgkmcnt(7)
    v_mfma_f32_16x16x32_bf16 v[16:19], v[128:131], v[168:171], v[16:19]
    v_mfma_f32_16x16x32_bf16 v[24:27], v[128:131], v[172:175], v[24:27]
    ds_read_b64_tr_b16 v[128:129], v192 offset:16384
    v_mfma_f32_16x16x32_bf16 v[4:7], v[132:135], v[160:163], v[4:7]
    ds_read_b64_tr_b16 v[130:131], v192 offset:18432
    v_mfma_f32_16x16x32_bf16 v[12:15], v[132:135], v[164:167], v[12:15]
    ds_read_b128 v[180:183], v202 offset:2048
    v_mfma_f32_16x16x32_bf16 v[20:23], v[132:135], v[168:171], v[20:23]
    v_mfma_f32_16x16x32_bf16 v[28:31], v[132:135], v[172:175], v[28:31]
    ds_read_b64_tr_b16 v[132:133], v193 offset:16384
    v_mfma_f32_16x16x32_bf16 v[32:35], v[136:139], v[160:163], v[32:35]
    ds_read_b64_tr_b16 v[134:135], v193 offset:18432
    v_mfma_f32_16x16x32_bf16 v[40:43], v[136:139], v[164:167], v[40:43]
    ds_read_b128 v[184:187], v203
    v_mfma_f32_16x16x32_bf16 v[48:51], v[136:139], v[168:171], v[48:51]
    v_mfma_f32_16x16x32_bf16 v[56:59], v[136:139], v[172:175], v[56:59]
    ds_read_b64_tr_b16 v[136:137], v194 offset:16384
    v_mfma_f32_16x16x32_bf16 v[36:39], v[140:143], v[160:163], v[36:39]
    ds_read_b64_tr_b16 v[138:139], v194 offset:18432
    v_mfma_f32_16x16x32_bf16 v[44:47], v[140:143], v[164:167], v[44:47]
    ds_read_b128 v[188:191], v203 offset:2048
    v_mfma_f32_16x16x32_bf16 v[52:55], v[140:143], v[168:171], v[52:55]
    v_mfma_f32_16x16x32_bf16 v[60:63], v[140:143], v[172:175], v[60:63]
    ds_read_b64_tr_b16 v[140:141], v195 offset:16384
    v_mfma_f32_16x16x32_bf16 v[64:67], v[144:147], v[160:163], v[64:67]
    ds_read_b64_tr_b16 v[142:143], v195 offset:18432
    v_mfma_f32_16x16x32_bf16 v[72:75], v[144:147], v[164:167], v[72:75]
    v_mfma_f32_16x16x32_bf16 v[80:83], v[144:147], v[168:171], v[80:83]
    v_mfma_f32_16x16x32_bf16 v[88:91], v[144:147], v[172:175], v[88:91]
    ds_read_b64_tr_b16 v[144:145], v192 offset:16640
    s_waitcnt lgkmcnt(8)
    v_mfma_f32_16x16x32_bf16 v[68:71], v[148:151], v[160:163], v[68:71]
    ds_read_b64_tr_b16 v[146:147], v192 offset:18688
    v_mfma_f32_16x16x32_bf16 v[76:79], v[148:151], v[164:167], v[76:79]
    v_mfma_f32_16x16x32_bf16 v[84:87], v[148:151], v[168:171], v[84:87]
    v_mfma_f32_16x16x32_bf16 v[92:95], v[148:151], v[172:175], v[92:95]
    ds_read_b64_tr_b16 v[148:149], v193 offset:16640
    v_mfma_f32_16x16x32_bf16 v[96:99], v[152:155], v[160:163], v[96:99]
    ds_read_b64_tr_b16 v[150:151], v193 offset:18688
    v_mfma_f32_16x16x32_bf16 v[104:107], v[152:155], v[164:167], v[104:107]
    v_mfma_f32_16x16x32_bf16 v[112:115], v[152:155], v[168:171], v[112:115]
    v_mfma_f32_16x16x32_bf16 v[120:123], v[152:155], v[172:175], v[120:123]
    ds_read_b64_tr_b16 v[152:153], v194 offset:16640
    v_mfma_f32_16x16x32_bf16 v[100:103], v[156:159], v[160:163], v[100:103]
    ds_read_b64_tr_b16 v[154:155], v194 offset:18688
    v_mfma_f32_16x16x32_bf16 v[108:111], v[156:159], v[164:167], v[108:111]
    v_mfma_f32_16x16x32_bf16 v[116:119], v[156:159], v[168:171], v[116:119]
    v_mfma_f32_16x16x32_bf16 v[124:127], v[156:159], v[172:175], v[124:127]
    ds_read_b64_tr_b16 v[156:157], v195 offset:16640
    v_mfma_f32_16x16x32_bf16 v[0:3], v[128:131], v[176:179], v[0:3]
    ds_read_b64_tr_b16 v[158:159], v195 offset:18688
    s_barrier
    v_mfma_f32_16x16x32_bf16 v[8:11], v[128:131], v[180:183], v[8:11]
    ds_read_b128 v[160:163], v200 offset:16384
    s_waitcnt lgkmcnt(7)
    v_mfma_f32_16x16x32_bf16 v[16:19], v[128:131], v[184:187], v[16:19]
    v_mfma_f32_16x16x32_bf16 v[24:27], v[128:131], v[188:191], v[24:27]
    ds_read_b64_tr_b16 v[128:129], v192 offset:32768
    v_mfma_f32_16x16x32_bf16 v[4:7], v[132:135], v[176:179], v[4:7]
    ds_read_b64_tr_b16 v[130:131], v192 offset:34816
    v_mfma_f32_16x16x32_bf16 v[12:15], v[132:135], v[180:183], v[12:15]
    ds_read_b128 v[164:167], v200 offset:18432
    v_mfma_f32_16x16x32_bf16 v[20:23], v[132:135], v[184:187], v[20:23]
    v_mfma_f32_16x16x32_bf16 v[28:31], v[132:135], v[188:191], v[28:31]
    ds_read_b64_tr_b16 v[132:133], v193 offset:32768
    v_mfma_f32_16x16x32_bf16 v[32:35], v[136:139], v[176:179], v[32:35]
    ds_read_b64_tr_b16 v[134:135], v193 offset:34816
    v_mfma_f32_16x16x32_bf16 v[40:43], v[136:139], v[180:183], v[40:43]
    ds_read_b128 v[168:171], v201 offset:16384
    v_mfma_f32_16x16x32_bf16 v[48:51], v[136:139], v[184:187], v[48:51]
    v_mfma_f32_16x16x32_bf16 v[56:59], v[136:139], v[188:191], v[56:59]
    ds_read_b64_tr_b16 v[136:137], v194 offset:32768
    v_mfma_f32_16x16x32_bf16 v[36:39], v[140:143], v[176:179], v[36:39]
    ds_read_b64_tr_b16 v[138:139], v194 offset:34816
    v_mfma_f32_16x16x32_bf16 v[44:47], v[140:143], v[180:183], v[44:47]
    ds_read_b128 v[172:175], v201 offset:18432
    v_mfma_f32_16x16x32_bf16 v[52:55], v[140:143], v[184:187], v[52:55]
    v_mfma_f32_16x16x32_bf16 v[60:63], v[140:143], v[188:191], v[60:63]
    ds_read_b64_tr_b16 v[140:141], v195 offset:32768
    v_mfma_f32_16x16x32_bf16 v[64:67], v[144:147], v[176:179], v[64:67]
    ds_read_b64_tr_b16 v[142:143], v195 offset:34816
    v_mfma_f32_16x16x32_bf16 v[72:75], v[144:147], v[180:183], v[72:75]
    v_mfma_f32_16x16x32_bf16 v[80:83], v[144:147], v[184:187], v[80:83]
    v_mfma_f32_16x16x32_bf16 v[88:91], v[144:147], v[188:191], v[88:91]
    ds_read_b64_tr_b16 v[144:145], v192 offset:33024
    s_waitcnt lgkmcnt(8)
    v_mfma_f32_16x16x32_bf16 v[68:71], v[148:151], v[176:179], v[68:71]
    ds_read_b64_tr_b16 v[146:147], v192 offset:35072
    v_mfma_f32_16x16x32_bf16 v[76:79], v[148:151], v[180:183], v[76:79]
    v_mfma_f32_16x16x32_bf16 v[84:87], v[148:151], v[184:187], v[84:87]
    v_mfma_f32_16x16x32_bf16 v[92:95], v[148:151], v[188:191], v[92:95]
    ds_read_b64_tr_b16 v[148:149], v193 offset:33024
    v_mfma_f32_16x16x32_bf16 v[96:99], v[152:155], v[176:179], v[96:99]
    ds_read_b64_tr_b16 v[150:151], v193 offset:35072
    v_mfma_f32_16x16x32_bf16 v[104:107], v[152:155], v[180:183], v[104:107]
    v_mfma_f32_16x16x32_bf16 v[112:115], v[152:155], v[184:187], v[112:115]
    v_mfma_f32_16x16x32_bf16 v[120:123], v[152:155], v[188:191], v[120:123]
    ds_read_b64_tr_b16 v[152:153], v194 offset:33024
    v_mfma_f32_16x16x32_bf16 v[100:103], v[156:159], v[176:179], v[100:103]
    ds_read_b64_tr_b16 v[154:155], v194 offset:35072
    v_mfma_f32_16x16x32_bf16 v[108:111], v[156:159], v[180:183], v[108:111]
    v_mfma_f32_16x16x32_bf16 v[116:119], v[156:159], v[184:187], v[116:119]
    v_mfma_f32_16x16x32_bf16 v[124:127], v[156:159], v[188:191], v[124:127]
    ds_read_b64_tr_b16 v[156:157], v195 offset:33024
    v_mfma_f32_16x16x32_bf16 v[0:3], v[128:131], v[160:163], v[0:3]
    ds_read_b64_tr_b16 v[158:159], v195 offset:35072
    s_barrier
    v_mfma_f32_16x16x32_bf16 v[8:11], v[128:131], v[164:167], v[8:11]
    ds_read_b128 v[176:179], v202 offset:16384
    s_waitcnt lgkmcnt(7)
    v_mfma_f32_16x16x32_bf16 v[16:19], v[128:131], v[168:171], v[16:19]
    v_mfma_f32_16x16x32_bf16 v[24:27], v[128:131], v[172:175], v[24:27]
    ds_read_b64_tr_b16 v[128:129], v192 offset:49152
    v_mfma_f32_16x16x32_bf16 v[4:7], v[132:135], v[160:163], v[4:7]
    ds_read_b64_tr_b16 v[130:131], v192 offset:51200
    v_mfma_f32_16x16x32_bf16 v[12:15], v[132:135], v[164:167], v[12:15]
    ds_read_b128 v[180:183], v202 offset:18432
    v_mfma_f32_16x16x32_bf16 v[20:23], v[132:135], v[168:171], v[20:23]
    v_mfma_f32_16x16x32_bf16 v[28:31], v[132:135], v[172:175], v[28:31]
    ds_read_b64_tr_b16 v[132:133], v193 offset:49152
    v_mfma_f32_16x16x32_bf16 v[32:35], v[136:139], v[160:163], v[32:35]
    ds_read_b64_tr_b16 v[134:135], v193 offset:51200
    v_mfma_f32_16x16x32_bf16 v[40:43], v[136:139], v[164:167], v[40:43]
    ds_read_b128 v[184:187], v203 offset:16384
    v_mfma_f32_16x16x32_bf16 v[48:51], v[136:139], v[168:171], v[48:51]
    v_mfma_f32_16x16x32_bf16 v[56:59], v[136:139], v[172:175], v[56:59]
    ds_read_b64_tr_b16 v[136:137], v194 offset:49152
    v_mfma_f32_16x16x32_bf16 v[36:39], v[140:143], v[160:163], v[36:39]
    ds_read_b64_tr_b16 v[138:139], v194 offset:51200
    v_mfma_f32_16x16x32_bf16 v[44:47], v[140:143], v[164:167], v[44:47]
    ds_read_b128 v[188:191], v203 offset:18432
    v_mfma_f32_16x16x32_bf16 v[52:55], v[140:143], v[168:171], v[52:55]
    v_mfma_f32_16x16x32_bf16 v[60:63], v[140:143], v[172:175], v[60:63]
    ds_read_b64_tr_b16 v[140:141], v195 offset:49152
    v_mfma_f32_16x16x32_bf16 v[64:67], v[144:147], v[160:163], v[64:67]
    ds_read_b64_tr_b16 v[142:143], v195 offset:51200
    v_mfma_f32_16x16x32_bf16 v[72:75], v[144:147], v[164:167], v[72:75]
    v_mfma_f32_16x16x32_bf16 v[80:83], v[144:147], v[168:171], v[80:83]
    v_mfma_f32_16x16x32_bf16 v[88:91], v[144:147], v[172:175], v[88:91]
    ds_read_b64_tr_b16 v[144:145], v192 offset:49408
    s_waitcnt lgkmcnt(8)
    v_mfma_f32_16x16x32_bf16 v[68:71], v[148:151], v[160:163], v[68:71]
    ds_read_b64_tr_b16 v[146:147], v192 offset:51456
    v_mfma_f32_16x16x32_bf16 v[76:79], v[148:151], v[164:167], v[76:79]
    v_mfma_f32_16x16x32_bf16 v[84:87], v[148:151], v[168:171], v[84:87]
    v_mfma_f32_16x16x32_bf16 v[92:95], v[148:151], v[172:175], v[92:95]
    ds_read_b64_tr_b16 v[148:149], v193 offset:49408
    v_mfma_f32_16x16x32_bf16 v[96:99], v[152:155], v[160:163], v[96:99]
    ds_read_b64_tr_b16 v[150:151], v193 offset:51456
    v_mfma_f32_16x16x32_bf16 v[104:107], v[152:155], v[164:167], v[104:107]
    v_mfma_f32_16x16x32_bf16 v[112:115], v[152:155], v[168:171], v[112:115]
    v_mfma_f32_16x16x32_bf16 v[120:123], v[152:155], v[172:175], v[120:123]
    ds_read_b64_tr_b16 v[152:153], v194 offset:49408
    v_mfma_f32_16x16x32_bf16 v[100:103], v[156:159], v[160:163], v[100:103]
    ds_read_b64_tr_b16 v[154:155], v194 offset:51456
    v_mfma_f32_16x16x32_bf16 v[108:111], v[156:159], v[164:167], v[108:111]
    v_mfma_f32_16x16x32_bf16 v[116:119], v[156:159], v[168:171], v[116:119]
    v_mfma_f32_16x16x32_bf16 v[124:127], v[156:159], v[172:175], v[124:127]
    ds_read_b64_tr_b16 v[156:157], v195 offset:49408
    v_mfma_f32_16x16x32_bf16 v[0:3], v[128:131], v[176:179], v[0:3]
    ds_read_b64_tr_b16 v[158:159], v195 offset:51456
    s_barrier
    v_mfma_f32_16x16x32_bf16 v[8:11], v[128:131], v[180:183], v[8:11]
    ds_read_b128 v[160:163], v200 offset:32768
    s_waitcnt lgkmcnt(7)
    v_mfma_f32_16x16x32_bf16 v[16:19], v[128:131], v[184:187], v[16:19]
    v_mfma_f32_16x16x32_bf16 v[24:27], v[128:131], v[188:191], v[24:27]
    ds_read_b64_tr_b16 v[128:129], v196
    v_mfma_f32_16x16x32_bf16 v[4:7], v[132:135], v[176:179], v[4:7]
    ds_read_b64_tr_b16 v[130:131], v196 offset:2048
    v_mfma_f32_16x16x32_bf16 v[12:15], v[132:135], v[180:183], v[12:15]
    ds_read_b128 v[164:167], v200 offset:34816
    v_mfma_f32_16x16x32_bf16 v[20:23], v[132:135], v[184:187], v[20:23]
    v_mfma_f32_16x16x32_bf16 v[28:31], v[132:135], v[188:191], v[28:31]
    ds_read_b64_tr_b16 v[132:133], v197
    v_mfma_f32_16x16x32_bf16 v[32:35], v[136:139], v[176:179], v[32:35]
    ds_read_b64_tr_b16 v[134:135], v197 offset:2048
    v_mfma_f32_16x16x32_bf16 v[40:43], v[136:139], v[180:183], v[40:43]
    ds_read_b128 v[168:171], v201 offset:32768
    v_mfma_f32_16x16x32_bf16 v[48:51], v[136:139], v[184:187], v[48:51]
    v_mfma_f32_16x16x32_bf16 v[56:59], v[136:139], v[188:191], v[56:59]
    ds_read_b64_tr_b16 v[136:137], v198
    v_mfma_f32_16x16x32_bf16 v[36:39], v[140:143], v[176:179], v[36:39]
    ds_read_b64_tr_b16 v[138:139], v198 offset:2048
    v_mfma_f32_16x16x32_bf16 v[44:47], v[140:143], v[180:183], v[44:47]
    ds_read_b128 v[172:175], v201 offset:34816
    v_mfma_f32_16x16x32_bf16 v[52:55], v[140:143], v[184:187], v[52:55]
    v_mfma_f32_16x16x32_bf16 v[60:63], v[140:143], v[188:191], v[60:63]
    ds_read_b64_tr_b16 v[140:141], v199
    v_mfma_f32_16x16x32_bf16 v[64:67], v[144:147], v[176:179], v[64:67]
    ds_read_b64_tr_b16 v[142:143], v199 offset:2048
    v_mfma_f32_16x16x32_bf16 v[72:75], v[144:147], v[180:183], v[72:75]
    v_mfma_f32_16x16x32_bf16 v[80:83], v[144:147], v[184:187], v[80:83]
    v_mfma_f32_16x16x32_bf16 v[88:91], v[144:147], v[188:191], v[88:91]
    ds_read_b64_tr_b16 v[144:145], v196 offset:256
    s_waitcnt lgkmcnt(8)
    v_mfma_f32_16x16x32_bf16 v[68:71], v[148:151], v[176:179], v[68:71]
    ds_read_b64_tr_b16 v[146:147], v196 offset:2304
    v_mfma_f32_16x16x32_bf16 v[76:79], v[148:151], v[180:183], v[76:79]
    v_mfma_f32_16x16x32_bf16 v[84:87], v[148:151], v[184:187], v[84:87]
    v_mfma_f32_16x16x32_bf16 v[92:95], v[148:151], v[188:191], v[92:95]
    ds_read_b64_tr_b16 v[148:149], v197 offset:256
    v_mfma_f32_16x16x32_bf16 v[96:99], v[152:155], v[176:179], v[96:99]
    ds_read_b64_tr_b16 v[150:151], v197 offset:2304
    v_mfma_f32_16x16x32_bf16 v[104:107], v[152:155], v[180:183], v[104:107]
    v_mfma_f32_16x16x32_bf16 v[112:115], v[152:155], v[184:187], v[112:115]
    v_mfma_f32_16x16x32_bf16 v[120:123], v[152:155], v[188:191], v[120:123]
    ds_read_b64_tr_b16 v[152:153], v198 offset:256
    v_mfma_f32_16x16x32_bf16 v[100:103], v[156:159], v[176:179], v[100:103]
    ds_read_b64_tr_b16 v[154:155], v198 offset:2304
    v_mfma_f32_16x16x32_bf16 v[108:111], v[156:159], v[180:183], v[108:111]
    v_mfma_f32_16x16x32_bf16 v[116:119], v[156:159], v[184:187], v[116:119]
    v_mfma_f32_16x16x32_bf16 v[124:127], v[156:159], v[188:191], v[124:127]
    ds_read_b64_tr_b16 v[156:157], v199 offset:256
    v_mfma_f32_16x16x32_bf16 v[0:3], v[128:131], v[160:163], v[0:3]
    ds_read_b64_tr_b16 v[158:159], v199 offset:2304
    s_barrier
    v_mfma_f32_16x16x32_bf16 v[8:11], v[128:131], v[164:167], v[8:11]
    ds_read_b128 v[176:179], v202 offset:32768
    s_waitcnt lgkmcnt(7)
    v_mfma_f32_16x16x32_bf16 v[16:19], v[128:131], v[168:171], v[16:19]
    v_mfma_f32_16x16x32_bf16 v[24:27], v[128:131], v[172:175], v[24:27]
    ds_read_b64_tr_b16 v[128:129], v196 offset:16384
    v_mfma_f32_16x16x32_bf16 v[4:7], v[132:135], v[160:163], v[4:7]
    ds_read_b64_tr_b16 v[130:131], v196 offset:18432
    v_mfma_f32_16x16x32_bf16 v[12:15], v[132:135], v[164:167], v[12:15]
    ds_read_b128 v[180:183], v202 offset:34816
    v_mfma_f32_16x16x32_bf16 v[20:23], v[132:135], v[168:171], v[20:23]
    v_mfma_f32_16x16x32_bf16 v[28:31], v[132:135], v[172:175], v[28:31]
    ds_read_b64_tr_b16 v[132:133], v197 offset:16384
    v_mfma_f32_16x16x32_bf16 v[32:35], v[136:139], v[160:163], v[32:35]
    ds_read_b64_tr_b16 v[134:135], v197 offset:18432
    v_mfma_f32_16x16x32_bf16 v[40:43], v[136:139], v[164:167], v[40:43]
    ds_read_b128 v[184:187], v203 offset:32768
    v_mfma_f32_16x16x32_bf16 v[48:51], v[136:139], v[168:171], v[48:51]
    v_mfma_f32_16x16x32_bf16 v[56:59], v[136:139], v[172:175], v[56:59]
    ds_read_b64_tr_b16 v[136:137], v198 offset:16384
    v_mfma_f32_16x16x32_bf16 v[36:39], v[140:143], v[160:163], v[36:39]
    ds_read_b64_tr_b16 v[138:139], v198 offset:18432
    v_mfma_f32_16x16x32_bf16 v[44:47], v[140:143], v[164:167], v[44:47]
    ds_read_b128 v[188:191], v203 offset:34816
    v_mfma_f32_16x16x32_bf16 v[52:55], v[140:143], v[168:171], v[52:55]
    v_mfma_f32_16x16x32_bf16 v[60:63], v[140:143], v[172:175], v[60:63]
    ds_read_b64_tr_b16 v[140:141], v199 offset:16384
    v_mfma_f32_16x16x32_bf16 v[64:67], v[144:147], v[160:163], v[64:67]
    ds_read_b64_tr_b16 v[142:143], v199 offset:18432
    v_mfma_f32_16x16x32_bf16 v[72:75], v[144:147], v[164:167], v[72:75]
    v_mfma_f32_16x16x32_bf16 v[80:83], v[144:147], v[168:171], v[80:83]
    v_mfma_f32_16x16x32_bf16 v[88:91], v[144:147], v[172:175], v[88:91]
    ds_read_b64_tr_b16 v[144:145], v196 offset:16640
    s_waitcnt lgkmcnt(8)
    v_mfma_f32_16x16x32_bf16 v[68:71], v[148:151], v[160:163], v[68:71]
    ds_read_b64_tr_b16 v[146:147], v196 offset:18688
    v_mfma_f32_16x16x32_bf16 v[76:79], v[148:151], v[164:167], v[76:79]
    v_mfma_f32_16x16x32_bf16 v[84:87], v[148:151], v[168:171], v[84:87]
    v_mfma_f32_16x16x32_bf16 v[92:95], v[148:151], v[172:175], v[92:95]
    ds_read_b64_tr_b16 v[148:149], v197 offset:16640
    v_mfma_f32_16x16x32_bf16 v[96:99], v[152:155], v[160:163], v[96:99]
    ds_read_b64_tr_b16 v[150:151], v197 offset:18688
    v_mfma_f32_16x16x32_bf16 v[104:107], v[152:155], v[164:167], v[104:107]
    v_mfma_f32_16x16x32_bf16 v[112:115], v[152:155], v[168:171], v[112:115]
    v_mfma_f32_16x16x32_bf16 v[120:123], v[152:155], v[172:175], v[120:123]
    ds_read_b64_tr_b16 v[152:153], v198 offset:16640
    v_mfma_f32_16x16x32_bf16 v[100:103], v[156:159], v[160:163], v[100:103]
    ds_read_b64_tr_b16 v[154:155], v198 offset:18688
    v_mfma_f32_16x16x32_bf16 v[108:111], v[156:159], v[164:167], v[108:111]
    v_mfma_f32_16x16x32_bf16 v[116:119], v[156:159], v[168:171], v[116:119]
    v_mfma_f32_16x16x32_bf16 v[124:127], v[156:159], v[172:175], v[124:127]
    ds_read_b64_tr_b16 v[156:157], v199 offset:16640
    v_mfma_f32_16x16x32_bf16 v[0:3], v[128:131], v[176:179], v[0:3]
    ds_read_b64_tr_b16 v[158:159], v199 offset:18688
    v_mfma_f32_16x16x32_bf16 v[8:11], v[128:131], v[180:183], v[8:11]
    ds_read_b128 v[160:163], v200
    s_waitcnt lgkmcnt(7)
    v_mfma_f32_16x16x32_bf16 v[16:19], v[128:131], v[184:187], v[16:19]
    v_mfma_f32_16x16x32_bf16 v[24:27], v[128:131], v[188:191], v[24:27]
    ds_read_b64_tr_b16 v[128:129], v192
    v_mfma_f32_16x16x32_bf16 v[4:7], v[132:135], v[176:179], v[4:7]
    ds_read_b64_tr_b16 v[130:131], v192 offset:2048
    v_mfma_f32_16x16x32_bf16 v[12:15], v[132:135], v[180:183], v[12:15]
    ds_read_b128 v[164:167], v200 offset:2048
    v_mfma_f32_16x16x32_bf16 v[20:23], v[132:135], v[184:187], v[20:23]
    v_mfma_f32_16x16x32_bf16 v[28:31], v[132:135], v[188:191], v[28:31]
    ds_read_b64_tr_b16 v[132:133], v193
    v_mfma_f32_16x16x32_bf16 v[32:35], v[136:139], v[176:179], v[32:35]
    ds_read_b64_tr_b16 v[134:135], v193 offset:2048
    v_mfma_f32_16x16x32_bf16 v[40:43], v[136:139], v[180:183], v[40:43]
    ds_read_b128 v[168:171], v201
    v_mfma_f32_16x16x32_bf16 v[48:51], v[136:139], v[184:187], v[48:51]
    v_mfma_f32_16x16x32_bf16 v[56:59], v[136:139], v[188:191], v[56:59]
    ds_read_b64_tr_b16 v[136:137], v194
    v_mfma_f32_16x16x32_bf16 v[36:39], v[140:143], v[176:179], v[36:39]
    ds_read_b64_tr_b16 v[138:139], v194 offset:2048
    v_mfma_f32_16x16x32_bf16 v[44:47], v[140:143], v[180:183], v[44:47]
    ds_read_b128 v[172:175], v201 offset:2048
    v_mfma_f32_16x16x32_bf16 v[52:55], v[140:143], v[184:187], v[52:55]
    v_mfma_f32_16x16x32_bf16 v[60:63], v[140:143], v[188:191], v[60:63]
    ds_read_b64_tr_b16 v[140:141], v195
    v_mfma_f32_16x16x32_bf16 v[64:67], v[144:147], v[176:179], v[64:67]
    ds_read_b64_tr_b16 v[142:143], v195 offset:2048
    v_mfma_f32_16x16x32_bf16 v[72:75], v[144:147], v[180:183], v[72:75]
    v_mfma_f32_16x16x32_bf16 v[80:83], v[144:147], v[184:187], v[80:83]
    v_mfma_f32_16x16x32_bf16 v[88:91], v[144:147], v[188:191], v[88:91]
    ds_read_b64_tr_b16 v[144:145], v192 offset:256
    s_waitcnt lgkmcnt(8)
    v_mfma_f32_16x16x32_bf16 v[68:71], v[148:151], v[176:179], v[68:71]
    ds_read_b64_tr_b16 v[146:147], v192 offset:2304
    v_mfma_f32_16x16x32_bf16 v[76:79], v[148:151], v[180:183], v[76:79]
    v_mfma_f32_16x16x32_bf16 v[84:87], v[148:151], v[184:187], v[84:87]
    v_mfma_f32_16x16x32_bf16 v[92:95], v[148:151], v[188:191], v[92:95]
    ds_read_b64_tr_b16 v[148:149], v193 offset:256
    v_mfma_f32_16x16x32_bf16 v[96:99], v[152:155], v[176:179], v[96:99]
    ds_read_b64_tr_b16 v[150:151], v193 offset:2304
    v_mfma_f32_16x16x32_bf16 v[104:107], v[152:155], v[180:183], v[104:107]
    v_mfma_f32_16x16x32_bf16 v[112:115], v[152:155], v[184:187], v[112:115]
    v_mfma_f32_16x16x32_bf16 v[120:123], v[152:155], v[188:191], v[120:123]
    ds_read_b64_tr_b16 v[152:153], v194 offset:256
    v_mfma_f32_16x16x32_bf16 v[100:103], v[156:159], v[176:179], v[100:103]
    ds_read_b64_tr_b16 v[154:155], v194 offset:2304
    v_mfma_f32_16x16x32_bf16 v[108:111], v[156:159], v[180:183], v[108:111]
    v_mfma_f32_16x16x32_bf16 v[116:119], v[156:159], v[184:187], v[116:119]
    v_mfma_f32_16x16x32_bf16 v[124:127], v[156:159], v[188:191], v[124:127]
    ds_read_b64_tr_b16 v[156:157], v195 offset:256
    v_mfma_f32_16x16x32_bf16 v[0:3], v[128:131], v[160:163], v[0:3]
    ds_read_b64_tr_b16 v[158:159], v195 offset:2304
    v_mfma_f32_16x16x32_bf16 v[8:11], v[128:131], v[164:167], v[8:11]
    ds_read_b128 v[176:179], v202
    s_waitcnt lgkmcnt(7)
    v_mfma_f32_16x16x32_bf16 v[16:19], v[128:131], v[168:171], v[16:19]
    v_mfma_f32_16x16x32_bf16 v[24:27], v[128:131], v[172:175], v[24:27]
    ds_read_b64_tr_b16 v[128:129], v192 offset:16384
    v_mfma_f32_16x16x32_bf16 v[4:7], v[132:135], v[160:163], v[4:7]
    ds_read_b64_tr_b16 v[130:131], v192 offset:18432
    v_mfma_f32_16x16x32_bf16 v[12:15], v[132:135], v[164:167], v[12:15]
    ds_read_b128 v[180:183], v202 offset:2048
    v_mfma_f32_16x16x32_bf16 v[20:23], v[132:135], v[168:171], v[20:23]
    v_mfma_f32_16x16x32_bf16 v[28:31], v[132:135], v[172:175], v[28:31]
    ds_read_b64_tr_b16 v[132:133], v193 offset:16384
    v_mfma_f32_16x16x32_bf16 v[32:35], v[136:139], v[160:163], v[32:35]
    ds_read_b64_tr_b16 v[134:135], v193 offset:18432
    v_mfma_f32_16x16x32_bf16 v[40:43], v[136:139], v[164:167], v[40:43]
    ds_read_b128 v[184:187], v203
    v_mfma_f32_16x16x32_bf16 v[48:51], v[136:139], v[168:171], v[48:51]
    v_mfma_f32_16x16x32_bf16 v[56:59], v[136:139], v[172:175], v[56:59]
    ds_read_b64_tr_b16 v[136:137], v194 offset:16384
    v_mfma_f32_16x16x32_bf16 v[36:39], v[140:143], v[160:163], v[36:39]
    ds_read_b64_tr_b16 v[138:139], v194 offset:18432
    v_mfma_f32_16x16x32_bf16 v[44:47], v[140:143], v[164:167], v[44:47]
    ds_read_b128 v[188:191], v203 offset:2048
    v_mfma_f32_16x16x32_bf16 v[52:55], v[140:143], v[168:171], v[52:55]
    v_mfma_f32_16x16x32_bf16 v[60:63], v[140:143], v[172:175], v[60:63]
    ds_read_b64_tr_b16 v[140:141], v195 offset:16384
    v_mfma_f32_16x16x32_bf16 v[64:67], v[144:147], v[160:163], v[64:67]
    ds_read_b64_tr_b16 v[142:143], v195 offset:18432
    v_mfma_f32_16x16x32_bf16 v[72:75], v[144:147], v[164:167], v[72:75]
    v_mfma_f32_16x16x32_bf16 v[80:83], v[144:147], v[168:171], v[80:83]
    v_mfma_f32_16x16x32_bf16 v[88:91], v[144:147], v[172:175], v[88:91]
    ds_read_b64_tr_b16 v[144:145], v192 offset:16640
    s_waitcnt lgkmcnt(8)
    v_mfma_f32_16x16x32_bf16 v[68:71], v[148:151], v[160:163], v[68:71]
    ds_read_b64_tr_b16 v[146:147], v192 offset:18688
    v_mfma_f32_16x16x32_bf16 v[76:79], v[148:151], v[164:167], v[76:79]
    v_mfma_f32_16x16x32_bf16 v[84:87], v[148:151], v[168:171], v[84:87]
    v_mfma_f32_16x16x32_bf16 v[92:95], v[148:151], v[172:175], v[92:95]
    ds_read_b64_tr_b16 v[148:149], v193 offset:16640
    v_mfma_f32_16x16x32_bf16 v[96:99], v[152:155], v[160:163], v[96:99]
    ds_read_b64_tr_b16 v[150:151], v193 offset:18688
    v_mfma_f32_16x16x32_bf16 v[104:107], v[152:155], v[164:167], v[104:107]
    v_mfma_f32_16x16x32_bf16 v[112:115], v[152:155], v[168:171], v[112:115]
    v_mfma_f32_16x16x32_bf16 v[120:123], v[152:155], v[172:175], v[120:123]
    ds_read_b64_tr_b16 v[152:153], v194 offset:16640
    v_mfma_f32_16x16x32_bf16 v[100:103], v[156:159], v[160:163], v[100:103]
    ds_read_b64_tr_b16 v[154:155], v194 offset:18688
    v_mfma_f32_16x16x32_bf16 v[108:111], v[156:159], v[164:167], v[108:111]
    v_mfma_f32_16x16x32_bf16 v[116:119], v[156:159], v[168:171], v[116:119]
    v_mfma_f32_16x16x32_bf16 v[124:127], v[156:159], v[172:175], v[124:127]
    ds_read_b64_tr_b16 v[156:157], v195 offset:16640
    v_mfma_f32_16x16x32_bf16 v[0:3], v[128:131], v[176:179], v[0:3]
    ds_read_b64_tr_b16 v[158:159], v195 offset:18688
    s_barrier
    v_mfma_f32_16x16x32_bf16 v[8:11], v[128:131], v[180:183], v[8:11]
    ds_read_b64 v[220:221], v208 offset:32768
    s_waitcnt lgkmcnt(7)
    v_mfma_f32_16x16x32_bf16 v[16:19], v[128:131], v[184:187], v[16:19]
    ds_read_b64 v[222:223], v209 offset:32768
    v_mfma_f32_16x16x32_bf16 v[24:27], v[128:131], v[188:191], v[24:27]
    ds_read_b64 v[224:225], v208 offset:34816
    v_mfma_f32_16x16x32_bf16 v[4:7], v[132:135], v[176:179], v[4:7]
    ds_read_b64 v[226:227], v209 offset:34816
    v_mfma_f32_16x16x32_bf16 v[12:15], v[132:135], v[180:183], v[12:15]
    ds_read_b64 v[228:229], v210 offset:32768
    v_mfma_f32_16x16x32_bf16 v[20:23], v[132:135], v[184:187], v[20:23]
    ds_read_b64 v[230:231], v211 offset:32768
    v_mfma_f32_16x16x32_bf16 v[28:31], v[132:135], v[188:191], v[28:31]
    ds_read_b64 v[232:233], v210 offset:34816
    v_mfma_f32_16x16x32_bf16 v[32:35], v[136:139], v[176:179], v[32:35]
    ds_read_b64 v[234:235], v211 offset:34816
    v_mfma_f32_16x16x32_bf16 v[40:43], v[136:139], v[180:183], v[40:43]
    ds_read_b64 v[236:237], v204
    v_mfma_f32_16x16x32_bf16 v[48:51], v[136:139], v[184:187], v[48:51]
    ds_read_b64 v[238:239], v205
    v_mfma_f32_16x16x32_bf16 v[56:59], v[136:139], v[188:191], v[56:59]
    ds_read_b64 v[240:241], v204 offset:2048
    v_mfma_f32_16x16x32_bf16 v[36:39], v[140:143], v[176:179], v[36:39]
    ds_read_b64 v[242:243], v205 offset:2048
    v_mfma_f32_16x16x32_bf16 v[44:47], v[140:143], v[180:183], v[44:47]
    v_cvt_pk_bf16_f32 v0, v0, v1
    v_cvt_pk_bf16_f32 v1, v2, v3
    v_mfma_f32_16x16x32_bf16 v[52:55], v[140:143], v[184:187], v[52:55]
    v_cvt_pk_bf16_f32 v8, v8, v9
    v_cvt_pk_bf16_f32 v9, v10, v11
    v_mfma_f32_16x16x32_bf16 v[60:63], v[140:143], v[188:191], v[60:63]
    v_cvt_pk_bf16_f32 v16, v16, v17
    v_cvt_pk_bf16_f32 v17, v18, v19
    v_mfma_f32_16x16x32_bf16 v[64:67], v[144:147], v[176:179], v[64:67]
    ds_read_b64 v[244:245], v206
    v_mfma_f32_16x16x32_bf16 v[72:75], v[144:147], v[180:183], v[72:75]
    v_cvt_pk_bf16_f32 v24, v24, v25
    v_cvt_pk_bf16_f32 v25, v26, v27
    v_mfma_f32_16x16x32_bf16 v[80:83], v[144:147], v[184:187], v[80:83]
    v_cvt_pk_bf16_f32 v2, v4, v5
    v_cvt_pk_bf16_f32 v3, v6, v7
    v_mfma_f32_16x16x32_bf16 v[88:91], v[144:147], v[188:191], v[88:91]
    v_cvt_pk_bf16_f32 v10, v12, v13
    v_cvt_pk_bf16_f32 v11, v14, v15
    s_waitcnt lgkmcnt(1)
    v_mfma_f32_16x16x32_bf16 v[68:71], v[148:151], v[176:179], v[68:71]
    ds_read_b64 v[246:247], v207
    v_mfma_f32_16x16x32_bf16 v[76:79], v[148:151], v[180:183], v[76:79]
    v_cvt_pk_bf16_f32 v18, v20, v21
    v_cvt_pk_bf16_f32 v19, v22, v23
    v_mfma_f32_16x16x32_bf16 v[84:87], v[148:151], v[184:187], v[84:87]
    v_cvt_pk_bf16_f32 v26, v28, v29
    v_cvt_pk_bf16_f32 v27, v30, v31
    v_mfma_f32_16x16x32_bf16 v[92:95], v[148:151], v[188:191], v[92:95]
    v_mfma_f32_16x16x32_bf16 v[96:99], v[152:155], v[176:179], v[96:99]
    ds_read_b64 v[248:249], v206 offset:2048
    v_mfma_f32_16x16x32_bf16 v[104:107], v[152:155], v[180:183], v[104:107]
    s_waitcnt vmcnt(1)
    ds_read_b64 v[250:251], v207 offset:2048
    v_mfma_f32_16x16x32_bf16 v[112:115], v[152:155], v[184:187], v[112:115]
    v_mfma_f32_16x16x32_bf16 v[120:123], v[152:155], v[188:191], v[120:123]
    v_mfma_f32_16x16x32_bf16 v[100:103], v[156:159], v[176:179], v[100:103]
    v_mfma_f32_16x16x32_bf16 v[108:111], v[156:159], v[180:183], v[108:111]
    v_mfma_f32_16x16x32_bf16 v[116:119], v[156:159], v[184:187], v[116:119]
    v_mfma_f32_16x16x32_bf16 v[124:127], v[156:159], v[188:191], v[124:127]
    v_mfma_f32_16x16x32_bf16 v[160:163], v[220:223], v[0:3], 0
    v_cvt_pk_bf16_f32 v32, v32, v33
    v_cvt_pk_bf16_f32 v33, v34, v35
    v_mfma_f32_16x16x32_bf16 v[168:171], v[220:223], v[8:11], 0
    v_cvt_pk_bf16_f32 v40, v40, v41
    v_cvt_pk_bf16_f32 v41, v42, v43
    v_mfma_f32_16x16x32_bf16 v[164:167], v[224:227], v[0:3], 0
    v_cvt_pk_bf16_f32 v34, v36, v37
    v_cvt_pk_bf16_f32 v35, v38, v39
    v_mfma_f32_16x16x32_bf16 v[172:175], v[224:227], v[8:11], 0
    v_cvt_pk_bf16_f32 v42, v44, v45
    v_cvt_pk_bf16_f32 v43, v46, v47
    v_mfma_f32_16x16x32_bf16 v[176:179], v[228:231], v[16:19], 0
    v_cvt_pk_bf16_f32 v48, v48, v49
    v_cvt_pk_bf16_f32 v49, v50, v51
    v_mfma_f32_16x16x32_bf16 v[184:187], v[228:231], v[24:27], 0
    v_cvt_pk_bf16_f32 v56, v56, v57
    v_cvt_pk_bf16_f32 v57, v58, v59
    v_mfma_f32_16x16x32_bf16 v[180:183], v[232:235], v[16:19], 0
    v_cvt_pk_bf16_f32 v50, v52, v53
    v_cvt_pk_bf16_f32 v51, v54, v55
    v_mfma_f32_16x16x32_bf16 v[188:191], v[232:235], v[24:27], 0
    v_cvt_pk_bf16_f32 v58, v60, v61
    v_cvt_pk_bf16_f32 v59, v62, v63
    s_waitcnt vmcnt(0)
    s_mov_b32 s62, 524288
L_ep9:
    v_readfirstlane_b32 s61, v212
    s_nop 1
    s_cmp_lg_u32 s61, 0
    s_cbranch_scc1 L_ep9_ok
    s_sub_u32 s62, s62, 1
    s_cbranch_scc1 L_ep9_ok
    buffer_load_dword v212, v213, s[48:51], 0 offen sc1
    s_waitcnt vmcnt(0)
    s_branch L_ep9
L_ep9_ok:
    v_mul_u32_u24 v218, 15, v215
    v_add_u32 v218, 1, v218
    v_lshrrev_b32 v218, v218, s61
    v_bfe_u32 v219, v218, 0, 2
    v_bfe_u32 v252, v218, 2, 2
    v_lshlrev_b32 v219, 14, v219
    v_lshl_or_b32 v252, v252, 30, v219
    v_bfe_u32 v219, v218, 4, 2
    v_bfe_u32 v253, v218, 6, 2
    v_lshlrev_b32 v219, 14, v219
    v_lshl_or_b32 v253, v253, 30, v219
    v_bfe_u32 v219, v218, 8, 2
    v_bfe_u32 v254, v218, 10, 2
    v_lshlrev_b32 v219, 14, v219
    v_lshl_or_b32 v254, v254, 30, v219
    v_bfe_u32 v219, v218, 12, 2
    v_bfe_u32 v255, v218, 14, 2
    v_lshlrev_b32 v219, 14, v219
    v_lshl_or_b32 v255, v255, 30, v219
    s_barrier
    v_mfma_f32_16x16x32_bf16 v[160:163], v[236:239], v[32:35], v[160:163]
    ds_read_b64 v[128:129], v204 offset:16384
    v_cvt_pk_bf16_f32 v64, v64, v65
    v_cvt_pk_bf16_f32 v65, v66, v67
    v_mfma_f32_16x16x32_bf16 v[168:171], v[236:239], v[40:43], v[168:171]
    ds_read_b64 v[130:131], v205 offset:16384
    v_cvt_pk_bf16_f32 v72, v72, v73
    v_cvt_pk_bf16_f32 v73, v74, v75
    v_mfma_f32_16x16x32_bf16 v[164:167], v[240:243], v[32:35], v[164:167]
    ds_read_b64 v[132:133], v204 offset:18432
    v_cvt_pk_bf16_f32 v66, v68, v69
    v_cvt_pk_bf16_f32 v67, v70, v71
    v_mfma_f32_16x16x32_bf16 v[172:175], v[240:243], v[40:43], v[172:175]
    ds_read_b64 v[134:135], v205 offset:18432
    v_cvt_pk_bf16_f32 v74, v76, v77
    v_cvt_pk_bf16_f32 v75, v78, v79
    s_waitcnt lgkmcnt(4)
    v_mfma_f32_16x16x32_bf16 v[176:179], v[244:247], v[48:51], v[176:179]
    ds_read_b64 v[136:137], v206 offset:16384
    v_cvt_pk_bf16_f32 v80, v80, v81
    v_cvt_pk_bf16_f32 v81, v82, v83
    v_mfma_f32_16x16x32_bf16 v[184:187], v[244:247], v[56:59], v[184:187]
    ds_read_b64 v[138:139], v207 offset:16384
    v_cvt_pk_bf16_f32 v88, v88, v89
    v_cvt_pk_bf16_f32 v89, v90, v91
    v_mfma_f32_16x16x32_bf16 v[180:183], v[248:251], v[48:51], v[180:183]
    ds_read_b64 v[140:141], v206 offset:18432
    v_cvt_pk_bf16_f32 v82, v84, v85
    v_cvt_pk_bf16_f32 v83, v86, v87
    v_mfma_f32_16x16x32_bf16 v[188:191], v[248:251], v[56:59], v[188:191]
    ds_read_b64 v[142:143], v207 offset:18432
    v_cvt_pk_bf16_f32 v90, v92, v93
    v_cvt_pk_bf16_f32 v91, v94, v95
    s_waitcnt lgkmcnt(4)
    v_mfma_f32_16x16x32_bf16 v[160:163], v[128:131], v[64:67], v[160:163]
    v_cvt_pk_bf16_f32 v96, v96, v97
    v_cvt_pk_bf16_f32 v97, v98, v99
    v_mfma_f32_16x16x32_bf16 v[168:171], v[128:131], v[72:75], v[168:171]
    v_cvt_pk_bf16_f32 v104, v104, v105
    v_cvt_pk_bf16_f32 v105, v106, v107
    v_mfma_f32_16x16x32_bf16 v[164:167], v[132:135], v[64:67], v[164:167]
    v_cvt_pk_bf16_f32 v98, v100, v101
    v_cvt_pk_bf16_f32 v99, v102, v103
    v_mfma_f32_16x16x32_bf16 v[172:175], v[132:135], v[72:75], v[172:175]
    v_cvt_pk_bf16_f32 v106, v108, v109
    v_cvt_pk_bf16_f32 v107, v110, v111
    s_waitcnt lgkmcnt(1)
    v_mfma_f32_16x16x32_bf16 v[176:179], v[136:139], v[80:83], v[176:179]
    v_cvt_pk_bf16_f32 v112, v112, v113
    v_cvt_pk_bf16_f32 v113, v114, v115
    v_mfma_f32_16x16x32_bf16 v[184:187], v[136:139], v[88:91], v[184:187]
    v_cvt_pk_bf16_f32 v120, v120, v121
    v_cvt_pk_bf16_f32 v121, v122, v123
    s_waitcnt lgkmcnt(0)
    v_mfma_f32_16x16x32_bf16 v[180:183], v[140:143], v[80:83], v[180:183]
    v_cvt_pk_bf16_f32 v114, v116, v117
    v_cvt_pk_bf16_f32 v115, v118, v119
    v_mfma_f32_16x16x32_bf16 v[188:191], v[140:143], v[88:91], v[188:191]
    v_cvt_pk_bf16_f32 v122, v124, v125
    v_cvt_pk_bf16_f32 v123, v126, v127
    s_barrier
    ds_read_b64 v[144:145], v208
    ds_read_b64 v[146:147], v209
    ds_read_b64 v[148:149], v208 offset:2048
    ds_read_b64 v[150:151], v209 offset:2048
    ds_read_b64 v[152:153], v210
    ds_read_b64 v[154:155], v211
    ds_read_b64 v[156:157], v210 offset:2048
    ds_read_b64 v[158:159], v211 offset:2048
    s_waitcnt lgkmcnt(6)
    v_mfma_f32_16x16x32_bf16 v[160:163], v[144:147], v[96:99], v[160:163]
    v_mfma_f32_16x16x32_bf16 v[168:171], v[144:147], v[104:107], v[168:171]
    s_waitcnt lgkmcnt(4)
    v_mfma_f32_16x16x32_bf16 v[164:167], v[148:151], v[96:99], v[164:167]
    v_mfma_f32_16x16x32_bf16 v[172:175], v[148:151], v[104:107], v[172:175]
    s_waitcnt lgkmcnt(2)
    v_mfma_f32_16x16x32_bf16 v[176:179], v[152:155], v[112:115], v[176:179]
    s_nop 1
    ds_write_b128 v216, v[160:163]
    v_mfma_f32_16x16x32_bf16 v[184:187], v[152:155], v[120:123], v[184:187]
    s_nop 0
    ds_write_b128 v216, v[164:167] offset:1024
    s_waitcnt lgkmcnt(1)
    v_mfma_f32_16x16x32_bf16 v[180:183], v[156:159], v[112:115], v[180:183]
    ds_write_b128 v216, v[168:171] offset:2048
    v_mfma_f32_16x16x32_bf16 v[188:191], v[156:159], v[120:123], v[188:191]
    ds_write_b128 v216, v[172:175] offset:3072
    s_waitcnt lgkmcnt(0)
    s_barrier
    ds_read_b128 v[128:131], v217
    ds_read_b128 v[132:135], v217 offset:1024
    ds_read_b128 v[136:139], v217 offset:2048
    ds_read_b128 v[140:143], v217 offset:3072
    s_waitcnt lgkmcnt(3)
    v_pk_add_f32 v[176:177], v[176:177], v[128:129]
    v_pk_add_f32 v[178:179], v[178:179], v[130:131]
    s_waitcnt lgkmcnt(2)
    v_pk_add_f32 v[180:181], v[180:181], v[132:133]
    v_pk_add_f32 v[182:183], v[182:183], v[134:135]
    s_waitcnt lgkmcnt(1)
    v_pk_add_f32 v[184:185], v[184:185], v[136:137]
    v_pk_add_f32 v[186:187], v[186:187], v[138:139]
    s_waitcnt lgkmcnt(0)
    v_pk_add_f32 v[188:189], v[188:189], v[140:141]
    v_pk_add_f32 v[190:191], v[190:191], v[142:143]
    v_max3_f32 v144, v176, v177, v178
    v_max3_f32 v146, v179, v180, v181
    v_max3_f32 v145, v184, v185, v186
    v_max3_f32 v147, v187, v188, v189
    v_max3_f32 v144, v144, v182, v183
    v_max_f32 v144, v144, v146
    v_max3_f32 v145, v145, v190, v191
    v_max_f32 v145, v145, v147
    s_nop 1
    v_permlane32_swap_b32 v144, v145
    v_max_f32 v144, v144, v145
    v_mov_b32 v145, v144
    s_nop 1
    v_permlane16_swap_b32 v144, v145
    v_max_f32 v144, v144, v145
    v_mul_f32 v144, s64, v144
    v_mov_b32 v145, v144
    s_nop 1
    v_permlane32_swap_b32 v144, v145
    v_pk_fma_f32 v[176:177], v[176:177], s[64:65], v[144:145] op_sel_hi:[1,1,0] neg_lo:[0,0,1] neg_hi:[0,0,1]
    v_pk_fma_f32 v[178:179], v[178:179], s[64:65], v[144:145] op_sel_hi:[1,1,0] neg_lo:[0,0,1] neg_hi:[0,0,1]
    v_pk_fma_f32 v[180:181], v[180:181], s[64:65], v[144:145] op_sel_hi:[1,1,0] neg_lo:[0,0,1] neg_hi:[0,0,1]
    v_pk_fma_f32 v[182:183], v[182:183], s[64:65], v[144:145] op_sel_hi:[1,1,0] neg_lo:[0,0,1] neg_hi:[0,0,1]
    v_pk_fma_f32 v[184:185], v[184:185], s[64:65], v[144:145] op_sel:[0,0,1] op_sel_hi:[1,1,1] neg_lo:[0,0,1] neg_hi:[0,0,1]
    v_pk_fma_f32 v[186:187], v[186:187], s[64:65], v[144:145] op_sel:[0,0,1] op_sel_hi:[1,1,1] neg_lo:[0,0,1] neg_hi:[0,0,1]
    v_pk_fma_f32 v[188:189], v[188:189], s[64:65], v[144:145] op_sel:[0,0,1] op_sel_hi:[1,1,1] neg_lo:[0,0,1] neg_hi:[0,0,1]
    v_pk_fma_f32 v[190:191], v[190:191], s[64:65], v[144:145] op_sel:[0,0,1] op_sel_hi:[1,1,1] neg_lo:[0,0,1] neg_hi:[0,0,1]
    v_exp_f32 v176, v176
    v_exp_f32 v177, v177
    v_exp_f32 v178, v178
    v_exp_f32 v179, v179
    v_exp_f32 v180, v180
    v_exp_f32 v181, v181
    v_exp_f32 v182, v182
    v_exp_f32 v183, v183
    v_exp_f32 v184, v184
    v_exp_f32 v185, v185
    v_exp_f32 v186, v186
    v_exp_f32 v187, v187
    v_exp_f32 v188, v188
    v_exp_f32 v189, v189
    v_exp_f32 v190, v190
    v_exp_f32 v191, v191
    buffer_store_dword v212, v213, s[44:47], s66 offen sc1
    v_pk_add_f32 v[146:147], v[176:177], v[178:179]
    v_pk_add_f32 v[148:149], v[180:181], v[182:183]
    v_pk_add_f32 v[150:151], v[184:185], v[186:187]
    v_pk_add_f32 v[152:153], v[188:189], v[190:191]
    v_pk_add_f32 v[146:147], v[146:147], v[148:149]
    v_pk_add_f32 v[150:151], v[150:151], v[152:153]
    v_add_f32 v144, v146, v147
    v_add_f32 v145, v150, v151
    s_nop 1
    v_permlane32_swap_b32 v144, v145
    v_add_f32 v144, v144, v145
    v_mov_b32 v145, v144
    s_nop 1
    v_permlane16_swap_b32 v144, v145
    v_add_f32 v144, v144, v145
    v_rcp_f32 v144, v144
    s_nop 0
    v_mov_b32 v145, v144
    s_nop 1
    v_permlane32_swap_b32 v144, v145
    v_pk_mul_f32 v[176:177], v[176:177], v[144:145] op_sel_hi:[1,0]
    v_pk_mul_f32 v[178:179], v[178:179], v[144:145] op_sel_hi:[1,0]
    v_pk_mul_f32 v[180:181], v[180:181], v[144:145] op_sel_hi:[1,0]
    v_pk_mul_f32 v[182:183], v[182:183], v[144:145] op_sel_hi:[1,0]
    v_cvt_pk_bf16_f32 v148, v176, v177
    v_cvt_pk_bf16_f32 v149, v178, v179
    v_cvt_pk_bf16_f32 v150, v180, v181
    v_cvt_pk_bf16_f32 v151, v182, v183
    v_and_or_b32 v148, v148, s40, v252
    v_and_or_b32 v149, v149, s40, v253
    v_and_or_b32 v150, v150, s40, v254
    v_and_or_b32 v151, v151, s40, v255
    buffer_store_dwordx4 v[148:151], v214, s[44:47], s63 offen offset:0 sc1
    v_pk_mul_f32 v[184:185], v[184:185], v[144:145] op_sel:[0,1] op_sel_hi:[1,1]
    v_pk_mul_f32 v[186:187], v[186:187], v[144:145] op_sel:[0,1] op_sel_hi:[1,1]
    v_pk_mul_f32 v[188:189], v[188:189], v[144:145] op_sel:[0,1] op_sel_hi:[1,1]
    v_pk_mul_f32 v[190:191], v[190:191], v[144:145] op_sel:[0,1] op_sel_hi:[1,1]
    v_cvt_pk_bf16_f32 v152, v184, v185
    v_cvt_pk_bf16_f32 v153, v186, v187
    v_cvt_pk_bf16_f32 v154, v188, v189
    v_cvt_pk_bf16_f32 v155, v190, v191
    v_and_or_b32 v152, v152, s40, v252
    v_and_or_b32 v153, v153, s40, v253
    v_and_or_b32 v154, v154, s40, v254
    v_and_or_b32 v155, v155, s40, v255
    buffer_store_dwordx4 v[152:155], v214, s[44:47], s63 offen offset:1024 sc1
    s_endpgm
L_Ucomp:
    s_and_b32 s23, s2, 3
    s_and_b32 s24, s2, 4
    s_bfe_u32 s56, s2, 0x20005
    s_add_u32 s24, s24, s56
    s_and_b32 s25, s22, 3
    s_add_u32 s29, s56, s25
    s_and_b32 s29, s29, 3
    s_lshr_b32 s56, s23, 1
    s_and_b32 s57, s23, 1
    s_and_b32 s58, s26, 1
    s_lshl_b32 s59, s58, 1
    s_xor_b32 s41, s57, 1
    s_add_u32 s41, s41, s59
    s_lshl_b32 s41, s41, 1
    s_add_u32 s59, s59, 4
    s_cmp_eq_u32 s25, 3
    s_cselect_b32 s56, s57, s56
    s_cselect_b32 s41, s59, s41
    s_xor_b32 s40, s56, 1
    v_lshrrev_b32 v2, 4, v1
    v_bfe_u32 v3, v1, 2, 2
    v_and_b32 v4, 3, v1
    v_bfe_u32 v5, v1, 4, 1
    v_lshl_or_b32 v5, v5, 2, v3
    v_xor_b32 v5, s41, v5
    v_lshlrev_b32 v5, 5, v5
    v_lshl_add_u32 v5, v4, 3, v5
    v_lshl_add_u32 v6, v2, 3, v3
    v_lshl_add_u32 v5, v6, 8, v5
    v_add_u32 v228, 0x4000, v5
    v_xor_b32 v229, 32, v228
    v_xor_b32 v230, 64, v228
    v_xor_b32 v231, 96, v228
    v_and_b32 v5, 15, v1
    v_bfe_u32 v6, v1, 1, 3
    v_xor_b32 v7, v6, v2
    v_lshlrev_b32 v7, 4, v7
    v_lshl_add_u32 v7, v5, 7, v7
    s_and_b32 s56, s26, 2
    s_add_u32 s56, s56, s40
    s_lshl_b32 s57, s56, 12
    v_add_u32 v224, s57, v7
    v_xor_b32 v225, 0x1000, v224
    v_xor_b32 v226, 64, v224
    v_xor_b32 v227, 64, v225
    v_mov_b32 v237, 0
    v_lshlrev_b32 v238, 4, v1
    v_lshlrev_b32 v242, 2, v1
    s_lshl_b32 s57, s56, 13
    s_add_u32 s57, s57, 32768
    v_add_u32 v232, s57, v238
    v_xor_b32 v233, 0x2000, v232
    s_add_u32 s56, s60, 65536
    v_add_u32 v240, s56, v238
    s_xor_b32 s56, s23, 3
    s_mov_b32 s57, 0
    s_and_b32 s58, s26, 1
    s_lshl_b32 s58, s58, 1
    s_xor_b32 s59, s40, 0
    s_add_u32 s58, s58, s59
    s_sub_u32 s59, s58, s23
    s_add_u32 s59, s59, 3
    s_and_b32 s59, s59, 3
    s_cmp_eq_u32 s25, 3
    s_cselect_b32 s56, s58, s56
    s_cselect_b32 s57, s59, s57
    s_lshl_b32 s58, s24, 2
    s_add_u32 s58, s58, s25
    s_lshl_b32 s58, s58, 2
    s_add_u32 s56, s56, s58
    s_mul_i32 s56, s56, 12
    s_add_u32 s56, s56, s26
    s_lshl_b32 s57, s57, 2
    s_add_u32 s56, s56, s57
    s_mul_i32 s57, s56, 2304
    s_add_u32 s28, s57, 1048576
    s_lshl_b32 s56, s56, 7
    s_add_u32 s63, s56, 7340032
    s_xor_b32 s56, s23, 2
    s_mov_b32 s57, 1
    s_and_b32 s58, s26, 1
    s_lshl_b32 s58, s58, 1
    s_xor_b32 s59, s40, 1
    s_add_u32 s58, s58, s59
    s_sub_u32 s59, s58, s23
    s_add_u32 s59, s59, 3
    s_and_b32 s59, s59, 3
    s_cmp_eq_u32 s25, 3
    s_cselect_b32 s56, s58, s56
    s_cselect_b32 s57, s59, s57
    s_lshl_b32 s58, s24, 2
    s_add_u32 s58, s58, s25
    s_lshl_b32 s58, s58, 2
    s_add_u32 s56, s56, s58
    s_mul_i32 s56, s56, 12
    s_add_u32 s56, s56, s26
    s_lshl_b32 s57, s57, 2
    s_add_u32 s56, s56, s57
    s_mul_i32 s57, s56, 2304
    s_add_u32 s30, s57, 1048576
    s_lshl_b32 s56, s56, 7
    s_add_u32 s64, s56, 7340032
    s_xor_b32 s56, s23, 1
    s_mov_b32 s57, 2
    s_lshl_b32 s58, s24, 2
    s_add_u32 s58, s58, s25
    s_lshl_b32 s58, s58, 2
    s_add_u32 s56, s56, s58
    s_mul_i32 s56, s56, 12
    s_add_u32 s56, s56, s26
    s_lshl_b32 s57, s57, 2
    s_add_u32 s56, s56, s57
    s_mul_i32 s57, s56, 2304
    s_add_u32 s31, s57, 1048576
    s_lshl_b32 s56, s56, 7
    s_add_u32 s65, s56, 7340032
    s_waitcnt lgkmcnt(0)
    s_mov_b32 s44, s18
    s_and_b32 s45, s19, 0xffff
    s_mov_b32 s46, 268435456
    s_mov_b32 s47, 0x20000
    s_mov_b32 s48, s16
    s_and_b32 s49, s17, 0xffff
    s_mov_b32 s50, 256
    s_mov_b32 s51, 0x20000
    s_cmp_eq_u32 s25, 3
    s_cbranch_scc1 L_Ucomp3
    s_barrier
    ds_read_b128 v[192:195], v224
    ds_read_b128 v[196:199], v224 offset:2048
    ds_read_b128 v[200:203], v225
    ds_read_b128 v[204:207], v225 offset:2048
    ds_read_b64_tr_b16 v[176:177], v228
    ds_read_b64_tr_b16 v[178:179], v228 offset:1024
    ds_read_b64_tr_b16 v[180:181], v229
    ds_read_b64_tr_b16 v[182:183], v229 offset:1024
    ds_read_b64_tr_b16 v[184:185], v230
    ds_read_b64_tr_b16 v[186:187], v230 offset:1024
    ds_read_b64_tr_b16 v[188:189], v231
    ds_read_b64_tr_b16 v[190:191], v231 offset:1024
    s_waitcnt lgkmcnt(6)
    v_mfma_f32_16x16x32_bf16 v[0:3], v[192:195], v[176:179], 0
    v_mfma_f32_16x16x32_bf16 v[4:7], v[196:199], v[176:179], 0
    ds_read_b128 v[208:211], v226
    v_mfma_f32_16x16x32_bf16 v[8:11], v[200:203], v[176:179], 0
    v_mfma_f32_16x16x32_bf16 v[12:15], v[204:207], v[176:179], 0
    ds_read_b64_tr_b16 v[176:177], v228 offset:8192
    s_waitcnt lgkmcnt(6)
    v_mfma_f32_16x16x32_bf16 v[16:19], v[192:195], v[180:183], 0
    ds_read_b64_tr_b16 v[178:179], v228 offset:9216
    v_mfma_f32_16x16x32_bf16 v[20:23], v[196:199], v[180:183], 0
    ds_read_b128 v[212:215], v226 offset:2048
    v_mfma_f32_16x16x32_bf16 v[24:27], v[200:203], v[180:183], 0
    v_mfma_f32_16x16x32_bf16 v[28:31], v[204:207], v[180:183], 0
    ds_read_b64_tr_b16 v[180:181], v229 offset:8192
    s_waitcnt lgkmcnt(7)
    v_mfma_f32_16x16x32_bf16 v[32:35], v[192:195], v[184:187], 0
    ds_read_b64_tr_b16 v[182:183], v229 offset:9216
    v_mfma_f32_16x16x32_bf16 v[36:39], v[196:199], v[184:187], 0
    ds_read_b128 v[216:219], v227
    v_mfma_f32_16x16x32_bf16 v[40:43], v[200:203], v[184:187], 0
    v_mfma_f32_16x16x32_bf16 v[44:47], v[204:207], v[184:187], 0
    ds_read_b64_tr_b16 v[184:185], v230 offset:8192
    s_waitcnt lgkmcnt(7)
    v_mfma_f32_16x16x32_bf16 v[48:51], v[192:195], v[188:191], 0
    ds_read_b64_tr_b16 v[186:187], v230 offset:9216
    v_mfma_f32_16x16x32_bf16 v[52:55], v[196:199], v[188:191], 0
    ds_read_b128 v[220:223], v227 offset:2048
    v_mfma_f32_16x16x32_bf16 v[56:59], v[200:203], v[188:191], 0
    v_mfma_f32_16x16x32_bf16 v[60:63], v[204:207], v[188:191], 0
    ds_read_b64_tr_b16 v[188:189], v231 offset:8192
    s_waitcnt lgkmcnt(7)
    v_mfma_f32_16x16x32_bf16 v[0:3], v[208:211], v[176:179], v[0:3]
    ds_read_b64_tr_b16 v[190:191], v231 offset:9216
    s_barrier
    v_mfma_f32_16x16x32_bf16 v[4:7], v[212:215], v[176:179], v[4:7]
    ds_read_b128 v[192:195], v224 offset:32768
    s_waitcnt lgkmcnt(6)
    v_mfma_f32_16x16x32_bf16 v[8:11], v[216:219], v[176:179], v[8:11]
    s_waitcnt lgkmcnt(3)
    v_mfma_f32_16x16x32_bf16 v[12:15], v[220:223], v[176:179], v[12:15]
    ds_read_b64_tr_b16 v[176:177], v228 offset:32768
    v_mfma_f32_16x16x32_bf16 v[16:19], v[208:211], v[180:183], v[16:19]
    ds_read_b64_tr_b16 v[178:179], v228 offset:33792
    v_mfma_f32_16x16x32_bf16 v[20:23], v[212:215], v[180:183], v[20:23]
    ds_read_b128 v[196:199], v224 offset:34816
    v_add_u32 v224, 65536, v224
    v_mfma_f32_16x16x32_bf16 v[24:27], v[216:219], v[180:183], v[24:27]
    v_mfma_f32_16x16x32_bf16 v[28:31], v[220:223], v[180:183], v[28:31]
    ds_read_b64_tr_b16 v[180:181], v229 offset:32768
    v_mfma_f32_16x16x32_bf16 v[32:35], v[208:211], v[184:187], v[32:35]
    ds_read_b64_tr_b16 v[182:183], v229 offset:33792
    v_mfma_f32_16x16x32_bf16 v[36:39], v[212:215], v[184:187], v[36:39]
    ds_read_b128 v[200:203], v225 offset:32768
    v_mfma_f32_16x16x32_bf16 v[40:43], v[216:219], v[184:187], v[40:43]
    v_mfma_f32_16x16x32_bf16 v[44:47], v[220:223], v[184:187], v[44:47]
    ds_read_b64_tr_b16 v[184:185], v230 offset:32768
    s_waitcnt lgkmcnt(7)
    v_mfma_f32_16x16x32_bf16 v[48:51], v[208:211], v[188:191], v[48:51]
    ds_read_b64_tr_b16 v[186:187], v230 offset:33792
    v_mfma_f32_16x16x32_bf16 v[52:55], v[212:215], v[188:191], v[52:55]
    ds_read_b128 v[204:207], v225 offset:34816
    v_add_u32 v225, 65536, v225
    v_mfma_f32_16x16x32_bf16 v[56:59], v[216:219], v[188:191], v[56:59]
    v_mfma_f32_16x16x32_bf16 v[60:63], v[220:223], v[188:191], v[60:63]
    ds_read_b64_tr_b16 v[188:189], v231 offset:32768
    s_waitcnt lgkmcnt(7)
    v_mfma_f32_16x16x32_bf16 v[0:3], v[192:195], v[176:179], v[0:3]
    ds_read_b64_tr_b16 v[190:191], v231 offset:33792
    v_mfma_f32_16x16x32_bf16 v[4:7], v[196:199], v[176:179], v[4:7]
    ds_read_b128 v[208:211], v226 offset:32768
    s_waitcnt lgkmcnt(6)
    v_mfma_f32_16x16x32_bf16 v[8:11], v[200:203], v[176:179], v[8:11]
    s_waitcnt lgkmcnt(3)
    v_mfma_f32_16x16x32_bf16 v[12:15], v[204:207], v[176:179], v[12:15]
    ds_read_b64_tr_b16 v[176:177], v228 offset:40960
    v_mfma_f32_16x16x32_bf16 v[16:19], v[192:195], v[180:183], v[16:19]
    ds_read_b64_tr_b16 v[178:179], v228 offset:41984
    v_add_u32 v228, 65536, v228
    v_mfma_f32_16x16x32_bf16 v[20:23], v[196:199], v[180:183], v[20:23]
    ds_read_b128 v[212:215], v226 offset:34816
    v_add_u32 v226, 65536, v226
    v_mfma_f32_16x16x32_bf16 v[24:27], v[200:203], v[180:183], v[24:27]
    v_mfma_f32_16x16x32_bf16 v[28:31], v[204:207], v[180:183], v[28:31]
    ds_read_b64_tr_b16 v[180:181], v229 offset:40960
    v_mfma_f32_16x16x32_bf16 v[32:35], v[192:195], v[184:187], v[32:35]
    ds_read_b64_tr_b16 v[182:183], v229 offset:41984
    v_add_u32 v229, 65536, v229
    v_mfma_f32_16x16x32_bf16 v[36:39], v[196:199], v[184:187], v[36:39]
    ds_read_b128 v[216:219], v227 offset:32768
    v_mfma_f32_16x16x32_bf16 v[40:43], v[200:203], v[184:187], v[40:43]
    v_mfma_f32_16x16x32_bf16 v[44:47], v[204:207], v[184:187], v[44:47]
    ds_read_b64_tr_b16 v[184:185], v230 offset:40960
    s_waitcnt lgkmcnt(7)
    v_mfma_f32_16x16x32_bf16 v[48:51], v[192:195], v[188:191], v[48:51]
    ds_read_b64_tr_b16 v[186:187], v230 offset:41984
    v_add_u32 v230, 65536, v230
    v_mfma_f32_16x16x32_bf16 v[52:55], v[196:199], v[188:191], v[52:55]
    ds_read_b128 v[220:223], v227 offset:34816
    v_add_u32 v227, 65536, v227
    v_mfma_f32_16x16x32_bf16 v[56:59], v[200:203], v[188:191], v[56:59]
    v_mfma_f32_16x16x32_bf16 v[60:63], v[204:207], v[188:191], v[60:63]
    ds_read_b64_tr_b16 v[188:189], v231 offset:40960
    s_waitcnt lgkmcnt(7)
    v_mfma_f32_16x16x32_bf16 v[0:3], v[208:211], v[176:179], v[0:3]
    ds_read_b64_tr_b16 v[190:191], v231 offset:41984
    v_add_u32 v231, 65536, v231
    s_barrier
    buffer_load_dword v236, v237, s[48:51], 0 offen sc1
    v_mfma_f32_16x16x32_bf16 v[4:7], v[212:215], v[176:179], v[4:7]
    ds_read_b128 v[192:195], v224
    s_waitcnt lgkmcnt(6)
    v_mfma_f32_16x16x32_bf16 v[8:11], v[216:219], v[176:179], v[8:11]
    s_waitcnt lgkmcnt(3)
    v_mfma_f32_16x16x32_bf16 v[12:15], v[220:223], v[176:179], v[12:15]
    ds_read_b64_tr_b16 v[176:177], v228
    v_mfma_f32_16x16x32_bf16 v[16:19], v[208:211], v[180:183], v[16:19]
    ds_read_b64_tr_b16 v[178:179], v228 offset:1024
    v_mfma_f32_16x16x32_bf16 v[20:23], v[212:215], v[180:183], v[20:23]
    ds_read_b128 v[196:199], v224 offset:2048
    v_mfma_f32_16x16x32_bf16 v[24:27], v[216:219], v[180:183], v[24:27]
    v_mfma_f32_16x16x32_bf16 v[28:31], v[220:223], v[180:183], v[28:31]
    ds_read_b64_tr_b16 v[180:181], v229
    v_mfma_f32_16x16x32_bf16 v[32:35], v[208:211], v[184:187], v[32:35]
    ds_read_b64_tr_b16 v[182:183], v229 offset:1024
    v_mfma_f32_16x16x32_bf16 v[36:39], v[212:215], v[184:187], v[36:39]
    ds_read_b128 v[200:203], v225
    v_mfma_f32_16x16x32_bf16 v[40:43], v[216:219], v[184:187], v[40:43]
    v_mfma_f32_16x16x32_bf16 v[44:47], v[220:223], v[184:187], v[44:47]
    ds_read_b64_tr_b16 v[184:185], v230
    s_waitcnt lgkmcnt(7)
    v_mfma_f32_16x16x32_bf16 v[48:51], v[208:211], v[188:191], v[48:51]
    ds_read_b64_tr_b16 v[186:187], v230 offset:1024
    v_mfma_f32_16x16x32_bf16 v[52:55], v[212:215], v[188:191], v[52:55]
    ds_read_b128 v[204:207], v225 offset:2048
    v_mfma_f32_16x16x32_bf16 v[56:59], v[216:219], v[188:191], v[56:59]
    v_mfma_f32_16x16x32_bf16 v[60:63], v[220:223], v[188:191], v[60:63]
    ds_read_b64_tr_b16 v[188:189], v231
    s_waitcnt lgkmcnt(8)
    v_mfma_f32_16x16x32_bf16 v[0:3], v[192:195], v[176:179], v[0:3]
    ds_read_b64_tr_b16 v[190:191], v231 offset:1024
    s_waitcnt lgkmcnt(8)
    v_mfma_f32_16x16x32_bf16 v[4:7], v[196:199], v[176:179], v[4:7]
    ds_read_b128 v[208:211], v226
    s_waitcnt lgkmcnt(6)
    v_mfma_f32_16x16x32_bf16 v[8:11], v[200:203], v[176:179], v[8:11]
    s_waitcnt lgkmcnt(3)
    v_mfma_f32_16x16x32_bf16 v[12:15], v[204:207], v[176:179], v[12:15]
    ds_read_b64_tr_b16 v[176:177], v228 offset:8192
    v_mfma_f32_16x16x32_bf16 v[16:19], v[192:195], v[180:183], v[16:19]
    ds_read_b64_tr_b16 v[178:179], v228 offset:9216
    v_mfma_f32_16x16x32_bf16 v[20:23], v[196:199], v[180:183], v[20:23]
    ds_read_b128 v[212:215], v226 offset:2048
    v_mfma_f32_16x16x32_bf16 v[24:27], v[200:203], v[180:183], v[24:27]
    v_mfma_f32_16x16x32_bf16 v[28:31], v[204:207], v[180:183], v[28:31]
    ds_read_b64_tr_b16 v[180:181], v229 offset:8192
    v_mfma_f32_16x16x32_bf16 v[32:35], v[192:195], v[184:187], v[32:35]
    ds_read_b64_tr_b16 v[182:183], v229 offset:9216
    v_mfma_f32_16x16x32_bf16 v[36:39], v[196:199], v[184:187], v[36:39]
    ds_read_b128 v[216:219], v227
    v_mfma_f32_16x16x32_bf16 v[40:43], v[200:203], v[184:187], v[40:43]
    v_mfma_f32_16x16x32_bf16 v[44:47], v[204:207], v[184:187], v[44:47]
    ds_read_b64_tr_b16 v[184:185], v230 offset:8192
    s_waitcnt lgkmcnt(7)
    v_mfma_f32_16x16x32_bf16 v[48:51], v[192:195], v[188:191], v[48:51]
    ds_read_b64_tr_b16 v[186:187], v230 offset:9216
    v_mfma_f32_16x16x32_bf16 v[52:55], v[196:199], v[188:191], v[52:55]
    ds_read_b128 v[220:223], v227 offset:2048
    v_mfma_f32_16x16x32_bf16 v[56:59], v[200:203], v[188:191], v[56:59]
    v_mfma_f32_16x16x32_bf16 v[60:63], v[204:207], v[188:191], v[60:63]
    ds_read_b64_tr_b16 v[188:189], v231 offset:8192
    s_waitcnt lgkmcnt(8)
    v_mfma_f32_16x16x32_bf16 v[0:3], v[208:211], v[176:179], v[0:3]
    ds_read_b64_tr_b16 v[190:191], v231 offset:9216
    s_barrier
    s_waitcnt lgkmcnt(7)
    v_mfma_f32_16x16x32_bf16 v[4:7], v[212:215], v[176:179], v[4:7]
    ds_read_b128 v[192:195], v224 offset:32768
    s_waitcnt lgkmcnt(6)
    v_mfma_f32_16x16x32_bf16 v[8:11], v[216:219], v[176:179], v[8:11]
    s_waitcnt lgkmcnt(3)
    v_mfma_f32_16x16x32_bf16 v[12:15], v[220:223], v[176:179], v[12:15]
    ds_read_b64_tr_b16 v[176:177], v228 offset:32768
    v_mfma_f32_16x16x32_bf16 v[16:19], v[208:211], v[180:183], v[16:19]
    ds_read_b64_tr_b16 v[178:179], v228 offset:33792
    v_mfma_f32_16x16x32_bf16 v[20:23], v[212:215], v[180:183], v[20:23]
    ds_read_b128 v[196:199], v224 offset:34816
    v_add_u32 v224, 65536, v224
    v_mfma_f32_16x16x32_bf16 v[24:27], v[216:219], v[180:183], v[24:27]
    v_mfma_f32_16x16x32_bf16 v[28:31], v[220:223], v[180:183], v[28:31]
    ds_read_b64_tr_b16 v[180:181], v229 offset:32768
    v_mfma_f32_16x16x32_bf16 v[32:35], v[208:211], v[184:187], v[32:35]
    ds_read_b64_tr_b16 v[182:183], v229 offset:33792
    v_mfma_f32_16x16x32_bf16 v[36:39], v[212:215], v[184:187], v[36:39]
    ds_read_b128 v[200:203], v225 offset:32768
    v_mfma_f32_16x16x32_bf16 v[40:43], v[216:219], v[184:187], v[40:43]
    v_mfma_f32_16x16x32_bf16 v[44:47], v[220:223], v[184:187], v[44:47]
    ds_read_b64_tr_b16 v[184:185], v230 offset:32768
    s_waitcnt lgkmcnt(7)
    v_mfma_f32_16x16x32_bf16 v[48:51], v[208:211], v[188:191], v[48:51]
    ds_read_b64_tr_b16 v[186:187], v230 offset:33792
    v_mfma_f32_16x16x32_bf16 v[52:55], v[212:215], v[188:191], v[52:55]
    ds_read_b128 v[204:207], v225 offset:34816
    v_add_u32 v225, 65536, v225
    v_mfma_f32_16x16x32_bf16 v[56:59], v[216:219], v[188:191], v[56:59]
    v_mfma_f32_16x16x32_bf16 v[60:63], v[220:223], v[188:191], v[60:63]
    ds_read_b64_tr_b16 v[188:189], v231 offset:32768
    s_waitcnt lgkmcnt(7)
    v_mfma_f32_16x16x32_bf16 v[0:3], v[192:195], v[176:179], v[0:3]
    ds_read_b64_tr_b16 v[190:191], v231 offset:33792
    v_mfma_f32_16x16x32_bf16 v[4:7], v[196:199], v[176:179], v[4:7]
    ds_read_b128 v[208:211], v226 offset:32768
    s_waitcnt lgkmcnt(6)
    v_mfma_f32_16x16x32_bf16 v[8:11], v[200:203], v[176:179], v[8:11]
    s_waitcnt lgkmcnt(3)
    v_mfma_f32_16x16x32_bf16 v[12:15], v[204:207], v[176:179], v[12:15]
    ds_read_b64_tr_b16 v[176:177], v228 offset:40960
    v_mfma_f32_16x16x32_bf16 v[16:19], v[192:195], v[180:183], v[16:19]
    ds_read_b64_tr_b16 v[178:179], v228 offset:41984
    v_add_u32 v228, 65536, v228
    v_mfma_f32_16x16x32_bf16 v[20:23], v[196:199], v[180:183], v[20:23]
    ds_read_b128 v[212:215], v226 offset:34816
    v_add_u32 v226, 65536, v226
    v_mfma_f32_16x16x32_bf16 v[24:27], v[200:203], v[180:183], v[24:27]
    v_mfma_f32_16x16x32_bf16 v[28:31], v[204:207], v[180:183], v[28:31]
    ds_read_b64_tr_b16 v[180:181], v229 offset:40960
    v_mfma_f32_16x16x32_bf16 v[32:35], v[192:195], v[184:187], v[32:35]
    ds_read_b64_tr_b16 v[182:183], v229 offset:41984
    v_add_u32 v229, 65536, v229
    v_mfma_f32_16x16x32_bf16 v[36:39], v[196:199], v[184:187], v[36:39]
    ds_read_b128 v[216:219], v227 offset:32768
    v_mfma_f32_16x16x32_bf16 v[40:43], v[200:203], v[184:187], v[40:43]
    v_mfma_f32_16x16x32_bf16 v[44:47], v[204:207], v[184:187], v[44:47]
    ds_read_b64_tr_b16 v[184:185], v230 offset:40960
    s_waitcnt lgkmcnt(7)
    v_mfma_f32_16x16x32_bf16 v[48:51], v[192:195], v[188:191], v[48:51]
    ds_read_b64_tr_b16 v[186:187], v230 offset:41984
    v_add_u32 v230, 65536, v230
    v_mfma_f32_16x16x32_bf16 v[52:55], v[196:199], v[188:191], v[52:55]
    ds_read_b128 v[220:223], v227 offset:34816
    v_add_u32 v227, 65536, v227
    v_mfma_f32_16x16x32_bf16 v[56:59], v[200:203], v[188:191], v[56:59]
    v_mfma_f32_16x16x32_bf16 v[60:63], v[204:207], v[188:191], v[60:63]
    ds_read_b64_tr_b16 v[188:189], v231 offset:40960
    s_waitcnt lgkmcnt(7)
    v_mfma_f32_16x16x32_bf16 v[0:3], v[208:211], v[176:179], v[0:3]
    ds_read_b64_tr_b16 v[190:191], v231 offset:41984
    v_add_u32 v231, 65536, v231
    s_waitcnt vmcnt(0)
    s_mov_b32 s62, 524288
L_ep10:
    v_readfirstlane_b32 s61, v236
    s_nop 1
    s_cmp_lg_u32 s61, 0
    s_cbranch_scc1 L_ep10_ok
    s_sub_u32 s62, s62, 1
    s_cbranch_scc1 L_ep10_ok
    buffer_load_dword v236, v237, s[48:51], 0 offen sc1
    s_waitcnt vmcnt(0)
    s_branch L_ep10
L_ep10_ok:
    s_nop 1
    v_mov_b32 v241, s61
    s_barrier
    v_mfma_f32_16x16x32_bf16 v[4:7], v[212:215], v[176:179], v[4:7]
    ds_read_b128 v[192:195], v224
    s_waitcnt lgkmcnt(2)
    v_mfma_f32_16x16x32_bf16 v[8:11], v[216:219], v[176:179], v[8:11]
    v_mfma_f32_16x16x32_bf16 v[12:15], v[220:223], v[176:179], v[12:15]
    ds_read_b64_tr_b16 v[176:177], v228
    v_mfma_f32_16x16x32_bf16 v[16:19], v[208:211], v[180:183], v[16:19]
    ds_read_b64_tr_b16 v[178:179], v228 offset:1024
    v_mfma_f32_16x16x32_bf16 v[20:23], v[212:215], v[180:183], v[20:23]
    ds_read_b128 v[196:199], v224 offset:2048
    v_subrev_u32 v224, 131072, v224
    v_mfma_f32_16x16x32_bf16 v[24:27], v[216:219], v[180:183], v[24:27]
    v_cvt_pk_bf16_f32 v80, v0, v1
    v_cvt_pk_bf16_f32 v81, v2, v3
    v_mfma_f32_16x16x32_bf16 v[28:31], v[220:223], v[180:183], v[28:31]
    ds_read_b64_tr_b16 v[180:181], v229
    v_cvt_pk_bf16_f32 v82, v4, v5
    v_cvt_pk_bf16_f32 v83, v6, v7
    v_mfma_f32_16x16x32_bf16 v[32:35], v[208:211], v[184:187], v[32:35]
    ds_read_b64_tr_b16 v[182:183], v229 offset:1024
    v_cvt_pk_bf16_f32 v128, v8, v9
    v_cvt_pk_bf16_f32 v129, v10, v11
    v_mfma_f32_16x16x32_bf16 v[36:39], v[212:215], v[184:187], v[36:39]
    ds_read_b128 v[200:203], v225
    v_cvt_pk_bf16_f32 v130, v12, v13
    v_cvt_pk_bf16_f32 v131, v14, v15
    v_mfma_f32_16x16x32_bf16 v[40:43], v[216:219], v[184:187], v[40:43]
    v_cvt_pk_bf16_f32 v84, v16, v17
    v_cvt_pk_bf16_f32 v85, v18, v19
    v_mfma_f32_16x16x32_bf16 v[44:47], v[220:223], v[184:187], v[44:47]
    ds_read_b64_tr_b16 v[184:185], v230
    v_cvt_pk_bf16_f32 v86, v20, v21
    v_cvt_pk_bf16_f32 v87, v22, v23
    s_waitcnt lgkmcnt(4)
    v_mfma_f32_16x16x32_bf16 v[48:51], v[208:211], v[188:191], v[48:51]
    ds_read_b64_tr_b16 v[186:187], v230 offset:1024
    v_cvt_pk_bf16_f32 v132, v24, v25
    v_cvt_pk_bf16_f32 v133, v26, v27
    v_mfma_f32_16x16x32_bf16 v[52:55], v[212:215], v[188:191], v[52:55]
    ds_read_b128 v[204:207], v225 offset:2048
    v_subrev_u32 v225, 131072, v225
    v_cvt_pk_bf16_f32 v134, v28, v29
    v_cvt_pk_bf16_f32 v135, v30, v31
    v_mfma_f32_16x16x32_bf16 v[56:59], v[216:219], v[188:191], v[56:59]
    v_cvt_pk_bf16_f32 v104, v32, v33
    v_cvt_pk_bf16_f32 v105, v34, v35
    v_mfma_f32_16x16x32_bf16 v[60:63], v[220:223], v[188:191], v[60:63]
    ds_read_b64_tr_b16 v[188:189], v231
    v_cvt_pk_bf16_f32 v106, v36, v37
    v_cvt_pk_bf16_f32 v107, v38, v39
    v_mfma_f32_16x16x32_bf16 v[64:67], v[192:195], v[176:179], 0
    ds_read_b64_tr_b16 v[190:191], v231 offset:1024
    v_cvt_pk_bf16_f32 v152, v40, v41
    v_cvt_pk_bf16_f32 v153, v42, v43
    v_mfma_f32_16x16x32_bf16 v[68:71], v[196:199], v[176:179], 0
    ds_read_b128 v[208:211], v226
    v_cvt_pk_bf16_f32 v154, v44, v45
    v_cvt_pk_bf16_f32 v155, v46, v47
    s_waitcnt lgkmcnt(4)
    v_mfma_f32_16x16x32_bf16 v[72:75], v[200:203], v[176:179], 0
    v_cvt_pk_bf16_f32 v108, v48, v49
    v_cvt_pk_bf16_f32 v109, v50, v51
    s_waitcnt lgkmcnt(3)
    v_mfma_f32_16x16x32_bf16 v[76:79], v[204:207], v[176:179], 0
    ds_read_b64_tr_b16 v[176:177], v228 offset:8192
    v_cvt_pk_bf16_f32 v110, v52, v53
    v_cvt_pk_bf16_f32 v111, v54, v55
    v_mfma_f32_16x16x32_bf16 v[0:3], v[192:195], v[180:183], 0
    ds_read_b64_tr_b16 v[178:179], v228 offset:9216
    v_subrev_u32 v228, 131072, v228
    v_cvt_pk_bf16_f32 v156, v56, v57
    v_cvt_pk_bf16_f32 v157, v58, v59
    v_mfma_f32_16x16x32_bf16 v[4:7], v[196:199], v[180:183], 0
    ds_read_b128 v[212:215], v226 offset:2048
    v_subrev_u32 v226, 131072, v226
    v_cvt_pk_bf16_f32 v158, v60, v61
    v_cvt_pk_bf16_f32 v159, v62, v63
    v_mfma_f32_16x16x32_bf16 v[8:11], v[200:203], v[180:183], 0
    v_mfma_f32_16x16x32_bf16 v[12:15], v[204:207], v[180:183], 0
    ds_read_b64_tr_b16 v[180:181], v229 offset:8192
    v_mfma_f32_16x16x32_bf16 v[16:19], v[192:195], v[184:187], 0
    ds_read_b64_tr_b16 v[182:183], v229 offset:9216
    v_subrev_u32 v229, 131072, v229
    v_mfma_f32_16x16x32_bf16 v[20:23], v[196:199], v[184:187], 0
    ds_read_b128 v[216:219], v227
    v_mfma_f32_16x16x32_bf16 v[24:27], v[200:203], v[184:187], 0
    v_mfma_f32_16x16x32_bf16 v[28:31], v[204:207], v[184:187], 0
    ds_read_b64_tr_b16 v[184:185], v230 offset:8192
    s_waitcnt lgkmcnt(5)
    v_mfma_f32_16x16x32_bf16 v[32:35], v[192:195], v[188:191], 0
    ds_read_b64_tr_b16 v[186:187], v230 offset:9216
    v_subrev_u32 v230, 131072, v230
    v_mfma_f32_16x16x32_bf16 v[36:39], v[196:199], v[188:191], 0
    ds_read_b128 v[220:223], v227 offset:2048
    v_subrev_u32 v227, 131072, v227
    v_mfma_f32_16x16x32_bf16 v[40:43], v[200:203], v[188:191], 0
    v_mfma_f32_16x16x32_bf16 v[44:47], v[204:207], v[188:191], 0
    ds_read_b64_tr_b16 v[188:189], v231 offset:8192
    v_mfma_f32_16x16x32_bf16 v[64:67], v[208:211], v[176:179], v[64:67]
    ds_read_b64_tr_b16 v[190:191], v231 offset:9216
    v_subrev_u32 v231, 131072, v231
    s_barrier
    s_waitcnt lgkmcnt(6)
    v_mfma_f32_16x16x32_bf16 v[68:71], v[212:215], v[176:179], v[68:71]
    ds_read_b128 v[192:195], v224
    s_waitcnt lgkmcnt(6)
    v_mfma_f32_16x16x32_bf16 v[72:75], v[216:219], v[176:179], v[72:75]
    s_waitcnt lgkmcnt(3)
    v_mfma_f32_16x16x32_bf16 v[76:79], v[220:223], v[176:179], v[76:79]
    ds_read_b64_tr_b16 v[176:177], v228
    v_mfma_f32_16x16x32_bf16 v[0:3], v[208:211], v[180:183], v[0:3]
    ds_read_b64_tr_b16 v[178:179], v228 offset:1024
    v_mfma_f32_16x16x32_bf16 v[4:7], v[212:215], v[180:183], v[4:7]
    ds_read_b128 v[196:199], v224 offset:2048
    v_mfma_f32_16x16x32_bf16 v[8:11], v[216:219], v[180:183], v[8:11]
    v_mfma_f32_16x16x32_bf16 v[12:15], v[220:223], v[180:183], v[12:15]
    ds_read_b64_tr_b16 v[180:181], v229
    v_mfma_f32_16x16x32_bf16 v[16:19], v[208:211], v[184:187], v[16:19]
    ds_read_b64_tr_b16 v[182:183], v229 offset:1024
    v_mfma_f32_16x16x32_bf16 v[20:23], v[212:215], v[184:187], v[20:23]
    ds_read_b128 v[200:203], v225
    v_mfma_f32_16x16x32_bf16 v[24:27], v[216:219], v[184:187], v[24:27]
    v_mfma_f32_16x16x32_bf16 v[28:31], v[220:223], v[184:187], v[28:31]
    ds_read_b64_tr_b16 v[184:185], v230
    s_waitcnt lgkmcnt(7)
    v_mfma_f32_16x16x32_bf16 v[32:35], v[208:211], v[188:191], v[32:35]
    ds_read_b64_tr_b16 v[186:187], v230 offset:1024
    v_mfma_f32_16x16x32_bf16 v[36:39], v[212:215], v[188:191], v[36:39]
    ds_read_b128 v[204:207], v225 offset:2048
    v_mfma_f32_16x16x32_bf16 v[40:43], v[216:219], v[188:191], v[40:43]
    v_mfma_f32_16x16x32_bf16 v[44:47], v[220:223], v[188:191], v[44:47]
    ds_read_b64_tr_b16 v[188:189], v231
    s_waitcnt lgkmcnt(8)
    v_mfma_f32_16x16x32_bf16 v[64:67], v[192:195], v[176:179], v[64:67]
    ds_read_b64_tr_b16 v[190:191], v231 offset:1024
    s_waitcnt lgkmcnt(8)
    v_mfma_f32_16x16x32_bf16 v[68:71], v[196:199], v[176:179], v[68:71]
    ds_read_b128 v[208:211], v226
    s_waitcnt lgkmcnt(6)
    v_mfma_f32_16x16x32_bf16 v[72:75], v[200:203], v[176:179], v[72:75]
    s_waitcnt lgkmcnt(3)
    v_mfma_f32_16x16x32_bf16 v[76:79], v[204:207], v[176:179], v[76:79]
    ds_read_b64_tr_b16 v[176:177], v228 offset:8192
    v_mfma_f32_16x16x32_bf16 v[0:3], v[192:195], v[180:183], v[0:3]
    ds_read_b64_tr_b16 v[178:179], v228 offset:9216
    v_mfma_f32_16x16x32_bf16 v[4:7], v[196:199], v[180:183], v[4:7]
    ds_read_b128 v[212:215], v226 offset:2048
    v_mfma_f32_16x16x32_bf16 v[8:11], v[200:203], v[180:183], v[8:11]
    v_mfma_f32_16x16x32_bf16 v[12:15], v[204:207], v[180:183], v[12:15]
    ds_read_b64_tr_b16 v[180:181], v229 offset:8192
    v_mfma_f32_16x16x32_bf16 v[16:19], v[192:195], v[184:187], v[16:19]
    ds_read_b64_tr_b16 v[182:183], v229 offset:9216
    v_mfma_f32_16x16x32_bf16 v[20:23], v[196:199], v[184:187], v[20:23]
    ds_read_b128 v[216:219], v227
    v_mfma_f32_16x16x32_bf16 v[24:27], v[200:203], v[184:187], v[24:27]
    v_mfma_f32_16x16x32_bf16 v[28:31], v[204:207], v[184:187], v[28:31]
    ds_read_b64_tr_b16 v[184:185], v230 offset:8192
    s_waitcnt lgkmcnt(7)
    v_mfma_f32_16x16x32_bf16 v[32:35], v[192:195], v[188:191], v[32:35]
    ds_read_b64_tr_b16 v[186:187], v230 offset:9216
    v_mfma_f32_16x16x32_bf16 v[36:39], v[196:199], v[188:191], v[36:39]
    ds_read_b128 v[220:223], v227 offset:2048
    v_mfma_f32_16x16x32_bf16 v[40:43], v[200:203], v[188:191], v[40:43]
    v_mfma_f32_16x16x32_bf16 v[44:47], v[204:207], v[188:191], v[44:47]
    ds_read_b64_tr_b16 v[188:189], v231 offset:8192
    s_waitcnt lgkmcnt(8)
    v_mfma_f32_16x16x32_bf16 v[64:67], v[208:211], v[176:179], v[64:67]
    ds_read_b64_tr_b16 v[190:191], v231 offset:9216
    s_barrier
    s_waitcnt lgkmcnt(7)
    v_mfma_f32_16x16x32_bf16 v[68:71], v[212:215], v[176:179], v[68:71]
    ds_read_b128 v[192:195], v224 offset:32768
    s_waitcnt lgkmcnt(6)
    v_mfma_f32_16x16x32_bf16 v[72:75], v[216:219], v[176:179], v[72:75]
    s_waitcnt lgkmcnt(3)
    v_mfma_f32_16x16x32_bf16 v[76:79], v[220:223], v[176:179], v[76:79]
    ds_read_b64_tr_b16 v[176:177], v228 offset:32768
    v_mfma_f32_16x16x32_bf16 v[0:3], v[208:211], v[180:183], v[0:3]
    ds_read_b64_tr_b16 v[178:179], v228 offset:33792
    v_mfma_f32_16x16x32_bf16 v[4:7], v[212:215], v[180:183], v[4:7]
    ds_read_b128 v[196:199], v224 offset:34816
    v_add_u32 v224, 65536, v224
    v_mfma_f32_16x16x32_bf16 v[8:11], v[216:219], v[180:183], v[8:11]
    v_mfma_f32_16x16x32_bf16 v[12:15], v[220:223], v[180:183], v[12:15]
    ds_read_b64_tr_b16 v[180:181], v229 offset:32768
    v_mfma_f32_16x16x32_bf16 v[16:19], v[208:211], v[184:187], v[16:19]
    ds_read_b64_tr_b16 v[182:183], v229 offset:33792
    v_mfma_f32_16x16x32_bf16 v[20:23], v[212:215], v[184:187], v[20:23]
    ds_read_b128 v[200:203], v225 offset:32768
    v_mfma_f32_16x16x32_bf16 v[24:27], v[216:219], v[184:187], v[24:27]
    v_mfma_f32_16x16x32_bf16 v[28:31], v[220:223], v[184:187], v[28:31]
    ds_read_b64_tr_b16 v[184:185], v230 offset:32768
    s_waitcnt lgkmcnt(7)
    v_mfma_f32_16x16x32_bf16 v[32:35], v[208:211], v[188:191], v[32:35]
    ds_read_b64_tr_b16 v[186:187], v230 offset:33792
    v_mfma_f32_16x16x32_bf16 v[36:39], v[212:215], v[188:191], v[36:39]
    ds_read_b128 v[204:207], v225 offset:34816
    v_add_u32 v225, 65536, v225
    v_mfma_f32_16x16x32_bf16 v[40:43], v[216:219], v[188:191], v[40:43]
    v_mfma_f32_16x16x32_bf16 v[44:47], v[220:223], v[188:191], v[44:47]
    ds_read_b64_tr_b16 v[188:189], v231 offset:32768
    s_waitcnt lgkmcnt(7)
    v_mfma_f32_16x16x32_bf16 v[64:67], v[192:195], v[176:179], v[64:67]
    ds_read_b64_tr_b16 v[190:191], v231 offset:33792
    v_mfma_f32_16x16x32_bf16 v[68:71], v[196:199], v[176:179], v[68:71]
    ds_read_b128 v[208:211], v226 offset:32768
    s_waitcnt lgkmcnt(6)
    v_mfma_f32_16x16x32_bf16 v[72:75], v[200:203], v[176:179], v[72:75]
    s_waitcnt lgkmcnt(3)
    v_mfma_f32_16x16x32_bf16 v[76:79], v[204:207], v[176:179], v[76:79]
    ds_read_b64_tr_b16 v[176:177], v228 offset:40960
    v_mfma_f32_16x16x32_bf16 v[0:3], v[192:195], v[180:183], v[0:3]
    ds_read_b64_tr_b16 v[178:179], v228 offset:41984
    v_add_u32 v228, 65536, v228
    v_mfma_f32_16x16x32_bf16 v[4:7], v[196:199], v[180:183], v[4:7]
    ds_read_b128 v[212:215], v226 offset:34816
    v_add_u32 v226, 65536, v226
    v_mfma_f32_16x16x32_bf16 v[8:11], v[200:203], v[180:183], v[8:11]
    v_mfma_f32_16x16x32_bf16 v[12:15], v[204:207], v[180:183], v[12:15]
    ds_read_b64_tr_b16 v[180:181], v229 offset:40960
    v_mfma_f32_16x16x32_bf16 v[16:19], v[192:195], v[184:187], v[16:19]
    ds_read_b64_tr_b16 v[182:183], v229 offset:41984
    v_add_u32 v229, 65536, v229
    v_mfma_f32_16x16x32_bf16 v[20:23], v[196:199], v[184:187], v[20:23]
    ds_read_b128 v[216:219], v227 offset:32768
    v_mfma_f32_16x16x32_bf16 v[24:27], v[200:203], v[184:187], v[24:27]
    v_mfma_f32_16x16x32_bf16 v[28:31], v[204:207], v[184:187], v[28:31]
    ds_read_b64_tr_b16 v[184:185], v230 offset:40960
    s_waitcnt lgkmcnt(7)
    v_mfma_f32_16x16x32_bf16 v[32:35], v[192:195], v[188:191], v[32:35]
    ds_read_b64_tr_b16 v[186:187], v230 offset:41984
    v_add_u32 v230, 65536, v230
    v_mfma_f32_16x16x32_bf16 v[36:39], v[196:199], v[188:191], v[36:39]
    ds_read_b128 v[220:223], v227 offset:34816
    v_add_u32 v227, 65536, v227
    v_mfma_f32_16x16x32_bf16 v[40:43], v[200:203], v[188:191], v[40:43]
    v_mfma_f32_16x16x32_bf16 v[44:47], v[204:207], v[188:191], v[44:47]
    ds_read_b64_tr_b16 v[188:189], v231 offset:40960
    s_waitcnt lgkmcnt(7)
    v_mfma_f32_16x16x32_bf16 v[64:67], v[208:211], v[176:179], v[64:67]
    ds_read_b64_tr_b16 v[190:191], v231 offset:41984
    v_add_u32 v231, 65536, v231
    s_barrier
    v_mfma_f32_16x16x32_bf16 v[68:71], v[212:215], v[176:179], v[68:71]
    ds_read_b128 v[192:195], v224
    s_waitcnt lgkmcnt(6)
    v_mfma_f32_16x16x32_bf16 v[72:75], v[216:219], v[176:179], v[72:75]
    s_waitcnt lgkmcnt(3)
    v_mfma_f32_16x16x32_bf16 v[76:79], v[220:223], v[176:179], v[76:79]
    ds_read_b64_tr_b16 v[176:177], v228
    v_mfma_f32_16x16x32_bf16 v[0:3], v[208:211], v[180:183], v[0:3]
    ds_read_b64_tr_b16 v[178:179], v228 offset:1024
    v_mfma_f32_16x16x32_bf16 v[4:7], v[212:215], v[180:183], v[4:7]
    ds_read_b128 v[196:199], v224 offset:2048
    v_mfma_f32_16x16x32_bf16 v[8:11], v[216:219], v[180:183], v[8:11]
    v_mfma_f32_16x16x32_bf16 v[12:15], v[220:223], v[180:183], v[12:15]
    ds_read_b64_tr_b16 v[180:181], v229
    v_mfma_f32_16x16x32_bf16 v[16:19], v[208:211], v[184:187], v[16:19]
    ds_read_b64_tr_b16 v[182:183], v229 offset:1024
    v_mfma_f32_16x16x32_bf16 v[20:23], v[212:215], v[184:187], v[20:23]
    ds_read_b128 v[200:203], v225
    v_mfma_f32_16x16x32_bf16 v[24:27], v[216:219], v[184:187], v[24:27]
    v_mfma_f32_16x16x32_bf16 v[28:31], v[220:223], v[184:187], v[28:31]
    ds_read_b64_tr_b16 v[184:185], v230
    s_waitcnt lgkmcnt(7)
    v_mfma_f32_16x16x32_bf16 v[32:35], v[208:211], v[188:191], v[32:35]
    ds_read_b64_tr_b16 v[186:187], v230 offset:1024
    v_mfma_f32_16x16x32_bf16 v[36:39], v[212:215], v[188:191], v[36:39]
    ds_read_b128 v[204:207], v225 offset:2048
    v_mfma_f32_16x16x32_bf16 v[40:43], v[216:219], v[188:191], v[40:43]
    v_mfma_f32_16x16x32_bf16 v[44:47], v[220:223], v[188:191], v[44:47]
    ds_read_b64_tr_b16 v[188:189], v231
    s_waitcnt lgkmcnt(8)
    v_mfma_f32_16x16x32_bf16 v[64:67], v[192:195], v[176:179], v[64:67]
    ds_read_b64_tr_b16 v[190:191], v231 offset:1024
    s_waitcnt lgkmcnt(8)
    v_mfma_f32_16x16x32_bf16 v[68:71], v[196:199], v[176:179], v[68:71]
    ds_read_b128 v[208:211], v226
    s_waitcnt lgkmcnt(6)
    v_mfma_f32_16x16x32_bf16 v[72:75], v[200:203], v[176:179], v[72:75]
    s_waitcnt lgkmcnt(3)
    v_mfma_f32_16x16x32_bf16 v[76:79], v[204:207], v[176:179], v[76:79]
    ds_read_b64_tr_b16 v[176:177], v228 offset:8192
    v_mfma_f32_16x16x32_bf16 v[0:3], v[192:195], v[180:183], v[0:3]
    ds_read_b64_tr_b16 v[178:179], v228 offset:9216
    v_mfma_f32_16x16x32_bf16 v[4:7], v[196:199], v[180:183], v[4:7]
    ds_read_b128 v[212:215], v226 offset:2048
    v_mfma_f32_16x16x32_bf16 v[8:11], v[200:203], v[180:183], v[8:11]
    v_mfma_f32_16x16x32_bf16 v[12:15], v[204:207], v[180:183], v[12:15]
    ds_read_b64_tr_b16 v[180:181], v229 offset:8192
    v_mfma_f32_16x16x32_bf16 v[16:19], v[192:195], v[184:187], v[16:19]
    ds_read_b64_tr_b16 v[182:183], v229 offset:9216
    v_mfma_f32_16x16x32_bf16 v[20:23], v[196:199], v[184:187], v[20:23]
    ds_read_b128 v[216:219], v227
    v_mfma_f32_16x16x32_bf16 v[24:27], v[200:203], v[184:187], v[24:27]
    v_mfma_f32_16x16x32_bf16 v[28:31], v[204:207], v[184:187], v[28:31]
    ds_read_b64_tr_b16 v[184:185], v230 offset:8192
    s_waitcnt lgkmcnt(7)
    v_mfma_f32_16x16x32_bf16 v[32:35], v[192:195], v[188:191], v[32:35]
    ds_read_b64_tr_b16 v[186:187], v230 offset:9216
    v_mfma_f32_16x16x32_bf16 v[36:39], v[196:199], v[188:191], v[36:39]
    ds_read_b128 v[220:223], v227 offset:2048
    v_mfma_f32_16x16x32_bf16 v[40:43], v[200:203], v[188:191], v[40:43]
    v_mfma_f32_16x16x32_bf16 v[44:47], v[204:207], v[188:191], v[44:47]
    ds_read_b64_tr_b16 v[188:189], v231 offset:8192
    s_waitcnt lgkmcnt(8)
    v_mfma_f32_16x16x32_bf16 v[64:67], v[208:211], v[176:179], v[64:67]
    ds_read_b64_tr_b16 v[190:191], v231 offset:9216
    s_barrier
    s_waitcnt lgkmcnt(7)
    v_mfma_f32_16x16x32_bf16 v[68:71], v[212:215], v[176:179], v[68:71]
    ds_read_b128 v[192:195], v224 offset:32768
    s_waitcnt lgkmcnt(6)
    v_mfma_f32_16x16x32_bf16 v[72:75], v[216:219], v[176:179], v[72:75]
    s_waitcnt lgkmcnt(3)
    v_mfma_f32_16x16x32_bf16 v[76:79], v[220:223], v[176:179], v[76:79]
    ds_read_b64_tr_b16 v[176:177], v228 offset:32768
    v_mfma_f32_16x16x32_bf16 v[0:3], v[208:211], v[180:183], v[0:3]
    ds_read_b64_tr_b16 v[178:179], v228 offset:33792
    v_mfma_f32_16x16x32_bf16 v[4:7], v[212:215], v[180:183], v[4:7]
    ds_read_b128 v[196:199], v224 offset:34816
    v_add_u32 v224, 65536, v224
    v_mfma_f32_16x16x32_bf16 v[8:11], v[216:219], v[180:183], v[8:11]
    v_cvt_pk_bf16_f32 v88, v64, v65
    v_cvt_pk_bf16_f32 v89, v66, v67
    v_mfma_f32_16x16x32_bf16 v[12:15], v[220:223], v[180:183], v[12:15]
    ds_read_b64_tr_b16 v[180:181], v229 offset:32768
    v_cvt_pk_bf16_f32 v90, v68, v69
    v_cvt_pk_bf16_f32 v91, v70, v71
    v_mfma_f32_16x16x32_bf16 v[16:19], v[208:211], v[184:187], v[16:19]
    ds_read_b64_tr_b16 v[182:183], v229 offset:33792
    v_cvt_pk_bf16_f32 v136, v72, v73
    v_cvt_pk_bf16_f32 v137, v74, v75
    v_mfma_f32_16x16x32_bf16 v[20:23], v[212:215], v[184:187], v[20:23]
    ds_read_b128 v[200:203], v225 offset:32768
    v_cvt_pk_bf16_f32 v138, v76, v77
    v_cvt_pk_bf16_f32 v139, v78, v79
    v_mfma_f32_16x16x32_bf16 v[24:27], v[216:219], v[184:187], v[24:27]
    v_cvt_pk_bf16_f32 v92, v0, v1
    v_cvt_pk_bf16_f32 v93, v2, v3
    v_mfma_f32_16x16x32_bf16 v[28:31], v[220:223], v[184:187], v[28:31]
    ds_read_b64_tr_b16 v[184:185], v230 offset:32768
    v_cvt_pk_bf16_f32 v94, v4, v5
    v_cvt_pk_bf16_f32 v95, v6, v7
    s_waitcnt lgkmcnt(4)
    v_mfma_f32_16x16x32_bf16 v[32:35], v[208:211], v[188:191], v[32:35]
    ds_read_b64_tr_b16 v[186:187], v230 offset:33792
    v_cvt_pk_bf16_f32 v140, v8, v9
    v_cvt_pk_bf16_f32 v141, v10, v11
    v_mfma_f32_16x16x32_bf16 v[36:39], v[212:215], v[188:191], v[36:39]
    ds_read_b128 v[204:207], v225 offset:34816
    v_add_u32 v225, 65536, v225
    v_cvt_pk_bf16_f32 v142, v12, v13
    v_cvt_pk_bf16_f32 v143, v14, v15
    v_mfma_f32_16x16x32_bf16 v[40:43], v[216:219], v[188:191], v[40:43]
    v_cvt_pk_bf16_f32 v112, v16, v17
    v_cvt_pk_bf16_f32 v113, v18, v19
    v_mfma_f32_16x16x32_bf16 v[44:47], v[220:223], v[188:191], v[44:47]
    ds_read_b64_tr_b16 v[188:189], v231 offset:32768
    v_cvt_pk_bf16_f32 v114, v20, v21
    v_cvt_pk_bf16_f32 v115, v22, v23
    v_mfma_f32_16x16x32_bf16 v[48:51], v[192:195], v[176:179], 0
    ds_read_b64_tr_b16 v[190:191], v231 offset:33792
    v_cvt_pk_bf16_f32 v160, v24, v25
    v_cvt_pk_bf16_f32 v161, v26, v27
    v_mfma_f32_16x16x32_bf16 v[52:55], v[196:199], v[176:179], 0
    ds_read_b128 v[208:211], v226 offset:32768
    v_cvt_pk_bf16_f32 v162, v28, v29
    v_cvt_pk_bf16_f32 v163, v30, v31
    s_waitcnt lgkmcnt(4)
    v_mfma_f32_16x16x32_bf16 v[56:59], v[200:203], v[176:179], 0
    v_cvt_pk_bf16_f32 v116, v32, v33
    v_cvt_pk_bf16_f32 v117, v34, v35
    s_waitcnt lgkmcnt(3)
    v_mfma_f32_16x16x32_bf16 v[60:63], v[204:207], v[176:179], 0
    ds_read_b64_tr_b16 v[176:177], v228 offset:40960
    v_cvt_pk_bf16_f32 v118, v36, v37
    v_cvt_pk_bf16_f32 v119, v38, v39
    v_mfma_f32_16x16x32_bf16 v[64:67], v[192:195], v[180:183], 0
    ds_read_b64_tr_b16 v[178:179], v228 offset:41984
    v_add_u32 v228, 65536, v228
    v_cvt_pk_bf16_f32 v164, v40, v41
    v_cvt_pk_bf16_f32 v165, v42, v43
    v_mfma_f32_16x16x32_bf16 v[68:71], v[196:199], v[180:183], 0
    ds_read_b128 v[212:215], v226 offset:34816
    v_add_u32 v226, 65536, v226
    v_cvt_pk_bf16_f32 v166, v44, v45
    v_cvt_pk_bf16_f32 v167, v46, v47
    v_mfma_f32_16x16x32_bf16 v[72:75], v[200:203], v[180:183], 0
    v_mfma_f32_16x16x32_bf16 v[76:79], v[204:207], v[180:183], 0
    ds_read_b64_tr_b16 v[180:181], v229 offset:40960
    v_mfma_f32_16x16x32_bf16 v[0:3], v[192:195], v[184:187], 0
    ds_read_b64_tr_b16 v[182:183], v229 offset:41984
    v_add_u32 v229, 65536, v229
    v_mfma_f32_16x16x32_bf16 v[4:7], v[196:199], v[184:187], 0
    ds_read_b128 v[216:219], v227 offset:32768
    v_mfma_f32_16x16x32_bf16 v[8:11], v[200:203], v[184:187], 0
    v_mfma_f32_16x16x32_bf16 v[12:15], v[204:207], v[184:187], 0
    ds_read_b64_tr_b16 v[184:185], v230 offset:40960
    s_waitcnt lgkmcnt(5)
    v_mfma_f32_16x16x32_bf16 v[16:19], v[192:195], v[188:191], 0
    ds_read_b64_tr_b16 v[186:187], v230 offset:41984
    v_add_u32 v230, 65536, v230
    v_mfma_f32_16x16x32_bf16 v[20:23], v[196:199], v[188:191], 0
    ds_read_b128 v[220:223], v227 offset:34816
    v_add_u32 v227, 65536, v227
    v_mfma_f32_16x16x32_bf16 v[24:27], v[200:203], v[188:191], 0
    v_mfma_f32_16x16x32_bf16 v[28:31], v[204:207], v[188:191], 0
    ds_read_b64_tr_b16 v[188:189], v231 offset:40960
    v_mfma_f32_16x16x32_bf16 v[48:51], v[208:211], v[176:179], v[48:51]
    ds_read_b64_tr_b16 v[190:191], v231 offset:41984
    v_add_u32 v231, 65536, v231
    s_barrier
    s_waitcnt lgkmcnt(6)
    v_mfma_f32_16x16x32_bf16 v[52:55], v[212:215], v[176:179], v[52:55]
    ds_read_b128 v[192:195], v224
    s_waitcnt lgkmcnt(6)
    v_mfma_f32_16x16x32_bf16 v[56:59], v[216:219], v[176:179], v[56:59]
    s_waitcnt lgkmcnt(3)
    v_mfma_f32_16x16x32_bf16 v[60:63], v[220:223], v[176:179], v[60:63]
    ds_read_b64_tr_b16 v[176:177], v228
    v_mfma_f32_16x16x32_bf16 v[64:67], v[208:211], v[180:183], v[64:67]
    ds_read_b64_tr_b16 v[178:179], v228 offset:1024
    v_mfma_f32_16x16x32_bf16 v[68:71], v[212:215], v[180:183], v[68:71]
    ds_read_b128 v[196:199], v224 offset:2048
    v_subrev_u32 v224, 131072, v224
    v_mfma_f32_16x16x32_bf16 v[72:75], v[216:219], v[180:183], v[72:75]
    v_mfma_f32_16x16x32_bf16 v[76:79], v[220:223], v[180:183], v[76:79]
    ds_read_b64_tr_b16 v[180:181], v229
    v_mfma_f32_16x16x32_bf16 v[0:3], v[208:211], v[184:187], v[0:3]
    ds_read_b64_tr_b16 v[182:183], v229 offset:1024
    v_mfma_f32_16x16x32_bf16 v[4:7], v[212:215], v[184:187], v[4:7]
    ds_read_b128 v[200:203], v225
    v_mfma_f32_16x16x32_bf16 v[8:11], v[216:219], v[184:187], v[8:11]
    v_mfma_f32_16x16x32_bf16 v[12:15], v[220:223], v[184:187], v[12:15]
    ds_read_b64_tr_b16 v[184:185], v230
    s_waitcnt lgkmcnt(7)
    v_mfma_f32_16x16x32_bf16 v[16:19], v[208:211], v[188:191], v[16:19]
    ds_read_b64_tr_b16 v[186:187], v230 offset:1024
    v_mfma_f32_16x16x32_bf16 v[20:23], v[212:215], v[188:191], v[20:23]
    ds_read_b128 v[204:207], v225 offset:2048
    v_subrev_u32 v225, 131072, v225
    v_mfma_f32_16x16x32_bf16 v[24:27], v[216:219], v[188:191], v[24:27]
    v_mfma_f32_16x16x32_bf16 v[28:31], v[220:223], v[188:191], v[28:31]
    ds_read_b64_tr_b16 v[188:189], v231
    s_waitcnt lgkmcnt(7)
    v_mfma_f32_16x16x32_bf16 v[48:51], v[192:195], v[176:179], v[48:51]
    ds_read_b64_tr_b16 v[190:191], v231 offset:1024
    v_mfma_f32_16x16x32_bf16 v[52:55], v[196:199], v[176:179], v[52:55]
    ds_read_b128 v[208:211], v226
    s_waitcnt lgkmcnt(6)
    v_mfma_f32_16x16x32_bf16 v[56:59], v[200:203], v[176:179], v[56:59]
    s_waitcnt lgkmcnt(3)
    v_mfma_f32_16x16x32_bf16 v[60:63], v[204:207], v[176:179], v[60:63]
    ds_read_b64_tr_b16 v[176:177], v228 offset:8192
    v_mfma_f32_16x16x32_bf16 v[64:67], v[192:195], v[180:183], v[64:67]
    ds_read_b64_tr_b16 v[178:179], v228 offset:9216
    v_subrev_u32 v228, 131072, v228
    v_mfma_f32_16x16x32_bf16 v[68:71], v[196:199], v[180:183], v[68:71]
    ds_read_b128 v[212:215], v226 offset:2048
    v_subrev_u32 v226, 131072, v226
    v_mfma_f32_16x16x32_bf16 v[72:75], v[200:203], v[180:183], v[72:75]
    v_mfma_f32_16x16x32_bf16 v[76:79], v[204:207], v[180:183], v[76:79]
    ds_read_b64_tr_b16 v[180:181], v229 offset:8192
    v_mfma_f32_16x16x32_bf16 v[0:3], v[192:195], v[184:187], v[0:3]
    ds_read_b64_tr_b16 v[182:183], v229 offset:9216
    v_subrev_u32 v229, 131072, v229
    v_mfma_f32_16x16x32_bf16 v[4:7], v[196:199], v[184:187], v[4:7]
    ds_read_b128 v[216:219], v227
    v_mfma_f32_16x16x32_bf16 v[8:11], v[200:203], v[184:187], v[8:11]
    v_mfma_f32_16x16x32_bf16 v[12:15], v[204:207], v[184:187], v[12:15]
    ds_read_b64_tr_b16 v[184:185], v230 offset:8192
    s_waitcnt lgkmcnt(7)
    v_mfma_f32_16x16x32_bf16 v[16:19], v[192:195], v[188:191], v[16:19]
    ds_read_b64_tr_b16 v[186:187], v230 offset:9216
    v_subrev_u32 v230, 131072, v230
    v_mfma_f32_16x16x32_bf16 v[20:23], v[196:199], v[188:191], v[20:23]
    ds_read_b128 v[220:223], v227 offset:2048
    v_subrev_u32 v227, 131072, v227
    v_mfma_f32_16x16x32_bf16 v[24:27], v[200:203], v[188:191], v[24:27]
    v_mfma_f32_16x16x32_bf16 v[28:31], v[204:207], v[188:191], v[28:31]
    ds_read_b64_tr_b16 v[188:189], v231 offset:8192
    s_waitcnt lgkmcnt(7)
    v_mfma_f32_16x16x32_bf16 v[48:51], v[208:211], v[176:179], v[48:51]
    ds_read_b64_tr_b16 v[190:191], v231 offset:9216
    v_subrev_u32 v231, 131072, v231
    s_barrier
    v_mfma_f32_16x16x32_bf16 v[52:55], v[212:215], v[176:179], v[52:55]
    ds_read_b128 v[192:195], v224
    s_waitcnt lgkmcnt(6)
    v_mfma_f32_16x16x32_bf16 v[56:59], v[216:219], v[176:179], v[56:59]
    s_waitcnt lgkmcnt(3)
    v_mfma_f32_16x16x32_bf16 v[60:63], v[220:223], v[176:179], v[60:63]
    ds_read_b64_tr_b16 v[176:177], v228
    v_mfma_f32_16x16x32_bf16 v[64:67], v[208:211], v[180:183], v[64:67]
    ds_read_b64_tr_b16 v[178:179], v228 offset:1024
    v_mfma_f32_16x16x32_bf16 v[68:71], v[212:215], v[180:183], v[68:71]
    ds_read_b128 v[196:199], v224 offset:2048
    v_mfma_f32_16x16x32_bf16 v[72:75], v[216:219], v[180:183], v[72:75]
    v_mfma_f32_16x16x32_bf16 v[76:79], v[220:223], v[180:183], v[76:79]
    ds_read_b64_tr_b16 v[180:181], v229
    v_mfma_f32_16x16x32_bf16 v[0:3], v[208:211], v[184:187], v[0:3]
    ds_read_b64_tr_b16 v[182:183], v229 offset:1024
    v_mfma_f32_16x16x32_bf16 v[4:7], v[212:215], v[184:187], v[4:7]
    ds_read_b128 v[200:203], v225
    v_mfma_f32_16x16x32_bf16 v[8:11], v[216:219], v[184:187], v[8:11]
    v_mfma_f32_16x16x32_bf16 v[12:15], v[220:223], v[184:187], v[12:15]
    ds_read_b64_tr_b16 v[184:185], v230
    s_waitcnt lgkmcnt(7)
    v_mfma_f32_16x16x32_bf16 v[16:19], v[208:211], v[188:191], v[16:19]
    ds_read_b64_tr_b16 v[186:187], v230 offset:1024
    v_mfma_f32_16x16x32_bf16 v[20:23], v[212:215], v[188:191], v[20:23]
    ds_read_b128 v[204:207], v225 offset:2048
    v_mfma_f32_16x16x32_bf16 v[24:27], v[216:219], v[188:191], v[24:27]
    v_mfma_f32_16x16x32_bf16 v[28:31], v[220:223], v[188:191], v[28:31]
    ds_read_b64_tr_b16 v[188:189], v231
    s_waitcnt lgkmcnt(8)
    v_mfma_f32_16x16x32_bf16 v[48:51], v[192:195], v[176:179], v[48:51]
    ds_read_b64_tr_b16 v[190:191], v231 offset:1024
    s_waitcnt lgkmcnt(8)
    v_mfma_f32_16x16x32_bf16 v[52:55], v[196:199], v[176:179], v[52:55]
    ds_read_b128 v[208:211], v226
    s_waitcnt lgkmcnt(6)
    v_mfma_f32_16x16x32_bf16 v[56:59], v[200:203], v[176:179], v[56:59]
    s_waitcnt lgkmcnt(3)
    v_mfma_f32_16x16x32_bf16 v[60:63], v[204:207], v[176:179], v[60:63]
    ds_read_b64_tr_b16 v[176:177], v228 offset:8192
    v_mfma_f32_16x16x32_bf16 v[64:67], v[192:195], v[180:183], v[64:67]
    ds_read_b64_tr_b16 v[178:179], v228 offset:9216
    v_mfma_f32_16x16x32_bf16 v[68:71], v[196:199], v[180:183], v[68:71]
    ds_read_b128 v[212:215], v226 offset:2048
    v_mfma_f32_16x16x32_bf16 v[72:75], v[200:203], v[180:183], v[72:75]
    v_mfma_f32_16x16x32_bf16 v[76:79], v[204:207], v[180:183], v[76:79]
    ds_read_b64_tr_b16 v[180:181], v229 offset:8192
    v_mfma_f32_16x16x32_bf16 v[0:3], v[192:195], v[184:187], v[0:3]
    ds_read_b64_tr_b16 v[182:183], v229 offset:9216
    v_mfma_f32_16x16x32_bf16 v[4:7], v[196:199], v[184:187], v[4:7]
    ds_read_b128 v[216:219], v227
    v_mfma_f32_16x16x32_bf16 v[8:11], v[200:203], v[184:187], v[8:11]
    v_mfma_f32_16x16x32_bf16 v[12:15], v[204:207], v[184:187], v[12:15]
    ds_read_b64_tr_b16 v[184:185], v230 offset:8192
    s_waitcnt lgkmcnt(7)
    v_mfma_f32_16x16x32_bf16 v[16:19], v[192:195], v[188:191], v[16:19]
    ds_read_b64_tr_b16 v[186:187], v230 offset:9216
    v_mfma_f32_16x16x32_bf16 v[20:23], v[196:199], v[188:191], v[20:23]
    ds_read_b128 v[220:223], v227 offset:2048
    v_mfma_f32_16x16x32_bf16 v[24:27], v[200:203], v[188:191], v[24:27]
    v_mfma_f32_16x16x32_bf16 v[28:31], v[204:207], v[188:191], v[28:31]
    ds_read_b64_tr_b16 v[188:189], v231 offset:8192
    s_waitcnt lgkmcnt(8)
    v_mfma_f32_16x16x32_bf16 v[48:51], v[208:211], v[176:179], v[48:51]
    ds_read_b64_tr_b16 v[190:191], v231 offset:9216
    s_barrier
    s_waitcnt lgkmcnt(7)
    v_mfma_f32_16x16x32_bf16 v[52:55], v[212:215], v[176:179], v[52:55]
    ds_read_b128 v[192:195], v224 offset:32768
    s_waitcnt lgkmcnt(6)
    v_mfma_f32_16x16x32_bf16 v[56:59], v[216:219], v[176:179], v[56:59]
    s_waitcnt lgkmcnt(3)
    v_mfma_f32_16x16x32_bf16 v[60:63], v[220:223], v[176:179], v[60:63]
    ds_read_b64_tr_b16 v[176:177], v228 offset:32768
    v_mfma_f32_16x16x32_bf16 v[64:67], v[208:211], v[180:183], v[64:67]
    ds_read_b64_tr_b16 v[178:179], v228 offset:33792
    v_mfma_f32_16x16x32_bf16 v[68:71], v[212:215], v[180:183], v[68:71]
    ds_read_b128 v[196:199], v224 offset:34816
    v_add_u32 v224, 65536, v224
    v_mfma_f32_16x16x32_bf16 v[72:75], v[216:219], v[180:183], v[72:75]
    v_mfma_f32_16x16x32_bf16 v[76:79], v[220:223], v[180:183], v[76:79]
    ds_read_b64_tr_b16 v[180:181], v229 offset:32768
    v_mfma_f32_16x16x32_bf16 v[0:3], v[208:211], v[184:187], v[0:3]
    ds_read_b64_tr_b16 v[182:183], v229 offset:33792
    v_mfma_f32_16x16x32_bf16 v[4:7], v[212:215], v[184:187], v[4:7]
    ds_read_b128 v[200:203], v225 offset:32768
    v_mfma_f32_16x16x32_bf16 v[8:11], v[216:219], v[184:187], v[8:11]
    v_mfma_f32_16x16x32_bf16 v[12:15], v[220:223], v[184:187], v[12:15]
    ds_read_b64_tr_b16 v[184:185], v230 offset:32768
    s_waitcnt lgkmcnt(7)
    v_mfma_f32_16x16x32_bf16 v[16:19], v[208:211], v[188:191], v[16:19]
    ds_read_b64_tr_b16 v[186:187], v230 offset:33792
    v_mfma_f32_16x16x32_bf16 v[20:23], v[212:215], v[188:191], v[20:23]
    ds_read_b128 v[204:207], v225 offset:34816
    v_add_u32 v225, 65536, v225
    v_mfma_f32_16x16x32_bf16 v[24:27], v[216:219], v[188:191], v[24:27]
    v_mfma_f32_16x16x32_bf16 v[28:31], v[220:223], v[188:191], v[28:31]
    ds_read_b64_tr_b16 v[188:189], v231 offset:32768
    s_waitcnt lgkmcnt(7)
    v_mfma_f32_16x16x32_bf16 v[48:51], v[192:195], v[176:179], v[48:51]
    ds_read_b64_tr_b16 v[190:191], v231 offset:33792
    v_mfma_f32_16x16x32_bf16 v[52:55], v[196:199], v[176:179], v[52:55]
    ds_read_b128 v[208:211], v226 offset:32768
    s_waitcnt lgkmcnt(6)
    v_mfma_f32_16x16x32_bf16 v[56:59], v[200:203], v[176:179], v[56:59]
    s_waitcnt lgkmcnt(3)
    v_mfma_f32_16x16x32_bf16 v[60:63], v[204:207], v[176:179], v[60:63]
    ds_read_b64_tr_b16 v[176:177], v228 offset:40960
    v_mfma_f32_16x16x32_bf16 v[64:67], v[192:195], v[180:183], v[64:67]
    ds_read_b64_tr_b16 v[178:179], v228 offset:41984
    v_add_u32 v228, 65536, v228
    v_mfma_f32_16x16x32_bf16 v[68:71], v[196:199], v[180:183], v[68:71]
    ds_read_b128 v[212:215], v226 offset:34816
    v_add_u32 v226, 65536, v226
    v_mfma_f32_16x16x32_bf16 v[72:75], v[200:203], v[180:183], v[72:75]
    v_mfma_f32_16x16x32_bf16 v[76:79], v[204:207], v[180:183], v[76:79]
    ds_read_b64_tr_b16 v[180:181], v229 offset:40960
    v_mfma_f32_16x16x32_bf16 v[0:3], v[192:195], v[184:187], v[0:3]
    ds_read_b64_tr_b16 v[182:183], v229 offset:41984
    v_add_u32 v229, 65536, v229
    v_mfma_f32_16x16x32_bf16 v[4:7], v[196:199], v[184:187], v[4:7]
    ds_read_b128 v[216:219], v227 offset:32768
    v_mfma_f32_16x16x32_bf16 v[8:11], v[200:203], v[184:187], v[8:11]
    v_mfma_f32_16x16x32_bf16 v[12:15], v[204:207], v[184:187], v[12:15]
    ds_read_b64_tr_b16 v[184:185], v230 offset:40960
    s_waitcnt lgkmcnt(7)
    v_mfma_f32_16x16x32_bf16 v[16:19], v[192:195], v[188:191], v[16:19]
    ds_read_b64_tr_b16 v[186:187], v230 offset:41984
    v_add_u32 v230, 65536, v230
    v_mfma_f32_16x16x32_bf16 v[20:23], v[196:199], v[188:191], v[20:23]
    ds_read_b128 v[220:223], v227 offset:34816
    v_add_u32 v227, 65536, v227
    v_mfma_f32_16x16x32_bf16 v[24:27], v[200:203], v[188:191], v[24:27]
    v_mfma_f32_16x16x32_bf16 v[28:31], v[204:207], v[188:191], v[28:31]
    ds_read_b64_tr_b16 v[188:189], v231 offset:40960
    s_waitcnt lgkmcnt(7)
    v_mfma_f32_16x16x32_bf16 v[48:51], v[208:211], v[176:179], v[48:51]
    ds_read_b64_tr_b16 v[190:191], v231 offset:41984
    v_add_u32 v231, 65536, v231
    s_barrier
    v_mfma_f32_16x16x32_bf16 v[52:55], v[212:215], v[176:179], v[52:55]
    ds_read_b128 v[192:195], v224
    s_waitcnt lgkmcnt(6)
    v_mfma_f32_16x16x32_bf16 v[56:59], v[216:219], v[176:179], v[56:59]
    s_waitcnt lgkmcnt(3)
    v_mfma_f32_16x16x32_bf16 v[60:63], v[220:223], v[176:179], v[60:63]
    ds_read_b64_tr_b16 v[176:177], v228
    v_mfma_f32_16x16x32_bf16 v[64:67], v[208:211], v[180:183], v[64:67]
    ds_read_b64_tr_b16 v[178:179], v228 offset:1024
    v_mfma_f32_16x16x32_bf16 v[68:71], v[212:215], v[180:183], v[68:71]
    ds_read_b128 v[196:199], v224 offset:2048
    v_mfma_f32_16x16x32_bf16 v[72:75], v[216:219], v[180:183], v[72:75]
    v_cvt_pk_bf16_f32 v96, v48, v49
    v_cvt_pk_bf16_f32 v97, v50, v51
    v_mfma_f32_16x16x32_bf16 v[76:79], v[220:223], v[180:183], v[76:79]
    ds_read_b64_tr_b16 v[180:181], v229
    v_cvt_pk_bf16_f32 v98, v52, v53
    v_cvt_pk_bf16_f32 v99, v54, v55
    v_mfma_f32_16x16x32_bf16 v[0:3], v[208:211], v[184:187], v[0:3]
    ds_read_b64_tr_b16 v[182:183], v229 offset:1024
    v_cvt_pk_bf16_f32 v144, v56, v57
    v_cvt_pk_bf16_f32 v145, v58, v59
    v_mfma_f32_16x16x32_bf16 v[4:7], v[212:215], v[184:187], v[4:7]
    ds_read_b128 v[200:203], v225
    v_cvt_pk_bf16_f32 v146, v60, v61
    v_cvt_pk_bf16_f32 v147, v62, v63
    v_mfma_f32_16x16x32_bf16 v[8:11], v[216:219], v[184:187], v[8:11]
    v_cvt_pk_bf16_f32 v100, v64, v65
    v_cvt_pk_bf16_f32 v101, v66, v67
    v_mfma_f32_16x16x32_bf16 v[12:15], v[220:223], v[184:187], v[12:15]
    ds_read_b64_tr_b16 v[184:185], v230
    v_cvt_pk_bf16_f32 v102, v68, v69
    v_cvt_pk_bf16_f32 v103, v70, v71
    s_waitcnt lgkmcnt(4)
    v_mfma_f32_16x16x32_bf16 v[16:19], v[208:211], v[188:191], v[16:19]
    ds_read_b64_tr_b16 v[186:187], v230 offset:1024
    v_cvt_pk_bf16_f32 v148, v72, v73
    v_cvt_pk_bf16_f32 v149, v74, v75
    v_mfma_f32_16x16x32_bf16 v[20:23], v[212:215], v[188:191], v[20:23]
    ds_read_b128 v[204:207], v225 offset:2048
    v_cvt_pk_bf16_f32 v150, v76, v77
    v_cvt_pk_bf16_f32 v151, v78, v79
    v_mfma_f32_16x16x32_bf16 v[24:27], v[216:219], v[188:191], v[24:27]
    v_cvt_pk_bf16_f32 v120, v0, v1
    v_cvt_pk_bf16_f32 v121, v2, v3
    v_mfma_f32_16x16x32_bf16 v[28:31], v[220:223], v[188:191], v[28:31]
    ds_read_b64_tr_b16 v[188:189], v231
    v_cvt_pk_bf16_f32 v122, v4, v5
    v_cvt_pk_bf16_f32 v123, v6, v7
    v_mfma_f32_16x16x32_bf16 v[32:35], v[192:195], v[176:179], 0
    ds_read_b64_tr_b16 v[190:191], v231 offset:1024
    v_cvt_pk_bf16_f32 v168, v8, v9
    v_cvt_pk_bf16_f32 v169, v10, v11
    v_mfma_f32_16x16x32_bf16 v[36:39], v[196:199], v[176:179], 0
    ds_read_b128 v[208:211], v226
    v_cvt_pk_bf16_f32 v170, v12, v13
    v_cvt_pk_bf16_f32 v171, v14, v15
    s_waitcnt lgkmcnt(4)
    v_mfma_f32_16x16x32_bf16 v[40:43], v[200:203], v[176:179], 0
    v_cvt_pk_bf16_f32 v124, v16, v17
    v_cvt_pk_bf16_f32 v125, v18, v19
    s_waitcnt lgkmcnt(3)
    v_mfma_f32_16x16x32_bf16 v[44:47], v[204:207], v[176:179], 0
    ds_read_b64_tr_b16 v[176:177], v228 offset:8192
    v_cvt_pk_bf16_f32 v126, v20, v21
    v_cvt_pk_bf16_f32 v127, v22, v23
    v_mfma_f32_16x16x32_bf16 v[48:51], v[192:195], v[180:183], 0
    ds_read_b64_tr_b16 v[178:179], v228 offset:9216
    v_cvt_pk_bf16_f32 v172, v24, v25
    v_cvt_pk_bf16_f32 v173, v26, v27
    v_mfma_f32_16x16x32_bf16 v[52:55], v[196:199], v[180:183], 0
    ds_read_b128 v[212:215], v226 offset:2048
    v_cvt_pk_bf16_f32 v174, v28, v29
    v_cvt_pk_bf16_f32 v175, v30, v31
    v_mfma_f32_16x16x32_bf16 v[56:59], v[200:203], v[180:183], 0
    v_mfma_f32_16x16x32_bf16 v[60:63], v[204:207], v[180:183], 0
    ds_read_b64_tr_b16 v[180:181], v229 offset:8192
    v_mfma_f32_16x16x32_bf16 v[64:67], v[192:195], v[184:187], 0
    ds_read_b64_tr_b16 v[182:183], v229 offset:9216
    v_mfma_f32_16x16x32_bf16 v[68:71], v[196:199], v[184:187], 0
    ds_read_b128 v[216:219], v227
    v_mfma_f32_16x16x32_bf16 v[72:75], v[200:203], v[184:187], 0
    v_mfma_f32_16x16x32_bf16 v[76:79], v[204:207], v[184:187], 0
    ds_read_b64_tr_b16 v[184:185], v230 offset:8192
    s_waitcnt lgkmcnt(6)
    v_mfma_f32_16x16x32_bf16 v[0:3], v[192:195], v[188:191], 0
    ds_read_b64_tr_b16 v[186:187], v230 offset:9216
    v_mfma_f32_16x16x32_bf16 v[4:7], v[196:199], v[188:191], 0
    ds_read_b128 v[220:223], v227 offset:2048
    v_mfma_f32_16x16x32_bf16 v[8:11], v[200:203], v[188:191], 0
    v_mfma_f32_16x16x32_bf16 v[12:15], v[204:207], v[188:191], 0
    ds_read_b64_tr_b16 v[188:189], v231 offset:8192
    s_waitcnt lgkmcnt(7)
    v_mfma_f32_16x16x32_bf16 v[32:35], v[208:211], v[176:179], v[32:35]
    ds_read_b64_tr_b16 v[190:191], v231 offset:9216
    s_barrier
    v_mfma_f32_16x16x32_bf16 v[36:39], v[212:215], v[176:179], v[36:39]
    ds_read_b128 v[192:195], v224 offset:32768
    s_waitcnt lgkmcnt(6)
    v_mfma_f32_16x16x32_bf16 v[40:43], v[216:219], v[176:179], v[40:43]
    s_waitcnt lgkmcnt(3)
    v_mfma_f32_16x16x32_bf16 v[44:47], v[220:223], v[176:179], v[44:47]
    ds_read_b64_tr_b16 v[176:177], v228 offset:32768
    v_mfma_f32_16x16x32_bf16 v[48:51], v[208:211], v[180:183], v[48:51]
    ds_read_b64_tr_b16 v[178:179], v228 offset:33792
    v_mfma_f32_16x16x32_bf16 v[52:55], v[212:215], v[180:183], v[52:55]
    ds_read_b128 v[196:199], v224 offset:34816
    v_add_u32 v224, 65536, v224
    v_mfma_f32_16x16x32_bf16 v[56:59], v[216:219], v[180:183], v[56:59]
    v_mfma_f32_16x16x32_bf16 v[60:63], v[220:223], v[180:183], v[60:63]
    ds_read_b64_tr_b16 v[180:181], v229 offset:32768
    v_mfma_f32_16x16x32_bf16 v[64:67], v[208:211], v[184:187], v[64:67]
    ds_read_b64_tr_b16 v[182:183], v229 offset:33792
    v_mfma_f32_16x16x32_bf16 v[68:71], v[212:215], v[184:187], v[68:71]
    ds_read_b128 v[200:203], v225 offset:32768
    v_mfma_f32_16x16x32_bf16 v[72:75], v[216:219], v[184:187], v[72:75]
    v_mfma_f32_16x16x32_bf16 v[76:79], v[220:223], v[184:187], v[76:79]
    ds_read_b64_tr_b16 v[184:185], v230 offset:32768
    s_waitcnt lgkmcnt(7)
    v_mfma_f32_16x16x32_bf16 v[0:3], v[208:211], v[188:191], v[0:3]
    ds_read_b64_tr_b16 v[186:187], v230 offset:33792
    v_mfma_f32_16x16x32_bf16 v[4:7], v[212:215], v[188:191], v[4:7]
    ds_read_b128 v[204:207], v225 offset:34816
    v_add_u32 v225, 65536, v225
    v_mfma_f32_16x16x32_bf16 v[8:11], v[216:219], v[188:191], v[8:11]
    v_mfma_f32_16x16x32_bf16 v[12:15], v[220:223], v[188:191], v[12:15]
    ds_read_b64_tr_b16 v[188:189], v231 offset:32768
    s_waitcnt lgkmcnt(7)
    v_mfma_f32_16x16x32_bf16 v[32:35], v[192:195], v[176:179], v[32:35]
    ds_read_b64_tr_b16 v[190:191], v231 offset:33792
    v_mfma_f32_16x16x32_bf16 v[36:39], v[196:199], v[176:179], v[36:39]
    ds_read_b128 v[208:211], v226 offset:32768
    s_waitcnt lgkmcnt(6)
    v_mfma_f32_16x16x32_bf16 v[40:43], v[200:203], v[176:179], v[40:43]
    s_waitcnt lgkmcnt(3)
    v_mfma_f32_16x16x32_bf16 v[44:47], v[204:207], v[176:179], v[44:47]
    ds_read_b64_tr_b16 v[176:177], v228 offset:40960
    v_mfma_f32_16x16x32_bf16 v[48:51], v[192:195], v[180:183], v[48:51]
    ds_read_b64_tr_b16 v[178:179], v228 offset:41984
    v_add_u32 v228, 65536, v228
    v_mfma_f32_16x16x32_bf16 v[52:55], v[196:199], v[180:183], v[52:55]
    ds_read_b128 v[212:215], v226 offset:34816
    v_add_u32 v226, 65536, v226
    v_mfma_f32_16x16x32_bf16 v[56:59], v[200:203], v[180:183], v[56:59]
    v_mfma_f32_16x16x32_bf16 v[60:63], v[204:207], v[180:183], v[60:63]
    ds_read_b64_tr_b16 v[180:181], v229 offset:40960
    v_mfma_f32_16x16x32_bf16 v[64:67], v[192:195], v[184:187], v[64:67]
    ds_read_b64_tr_b16 v[182:183], v229 offset:41984
    v_add_u32 v229, 65536, v229
    v_mfma_f32_16x16x32_bf16 v[68:71], v[196:199], v[184:187], v[68:71]
    ds_read_b128 v[216:219], v227 offset:32768
    v_mfma_f32_16x16x32_bf16 v[72:75], v[200:203], v[184:187], v[72:75]
    v_mfma_f32_16x16x32_bf16 v[76:79], v[204:207], v[184:187], v[76:79]
    ds_read_b64_tr_b16 v[184:185], v230 offset:40960
    s_waitcnt lgkmcnt(7)
    v_mfma_f32_16x16x32_bf16 v[0:3], v[192:195], v[188:191], v[0:3]
    ds_read_b64_tr_b16 v[186:187], v230 offset:41984
    v_add_u32 v230, 65536, v230
    v_mfma_f32_16x16x32_bf16 v[4:7], v[196:199], v[188:191], v[4:7]
    ds_read_b128 v[220:223], v227 offset:34816
    v_add_u32 v227, 65536, v227
    v_mfma_f32_16x16x32_bf16 v[8:11], v[200:203], v[188:191], v[8:11]
    v_mfma_f32_16x16x32_bf16 v[12:15], v[204:207], v[188:191], v[12:15]
    ds_read_b64_tr_b16 v[188:189], v231 offset:40960
    s_waitcnt lgkmcnt(7)
    v_mfma_f32_16x16x32_bf16 v[32:35], v[208:211], v[176:179], v[32:35]
    ds_read_b64_tr_b16 v[190:191], v231 offset:41984
    v_add_u32 v231, 65536, v231
    s_barrier
    v_mfma_f32_16x16x32_bf16 v[36:39], v[212:215], v[176:179], v[36:39]
    ds_read_b128 v[192:195], v224
    s_waitcnt lgkmcnt(6)
    v_mfma_f32_16x16x32_bf16 v[40:43], v[216:219], v[176:179], v[40:43]
    s_waitcnt lgkmcnt(3)
    v_mfma_f32_16x16x32_bf16 v[44:47], v[220:223], v[176:179], v[44:47]
    ds_read_b64_tr_b16 v[176:177], v228
    v_mfma_f32_16x16x32_bf16 v[48:51], v[208:211], v[180:183], v[48:51]
    ds_read_b64_tr_b16 v[178:179], v228 offset:1024
    v_mfma_f32_16x16x32_bf16 v[52:55], v[212:215], v[180:183], v[52:55]
    ds_read_b128 v[196:199], v224 offset:2048
    v_subrev_u32 v224, 131072, v224
    v_mfma_f32_16x16x32_bf16 v[56:59], v[216:219], v[180:183], v[56:59]
    v_mfma_f32_16x16x32_bf16 v[60:63], v[220:223], v[180:183], v[60:63]
    ds_read_b64_tr_b16 v[180:181], v229
    v_mfma_f32_16x16x32_bf16 v[64:67], v[208:211], v[184:187], v[64:67]
    ds_read_b64_tr_b16 v[182:183], v229 offset:1024
    v_mfma_f32_16x16x32_bf16 v[68:71], v[212:215], v[184:187], v[68:71]
    ds_read_b128 v[200:203], v225
    v_mfma_f32_16x16x32_bf16 v[72:75], v[216:219], v[184:187], v[72:75]
    v_mfma_f32_16x16x32_bf16 v[76:79], v[220:223], v[184:187], v[76:79]
    ds_read_b64_tr_b16 v[184:185], v230
    s_waitcnt lgkmcnt(7)
    v_mfma_f32_16x16x32_bf16 v[0:3], v[208:211], v[188:191], v[0:3]
    ds_read_b64_tr_b16 v[186:187], v230 offset:1024
    v_mfma_f32_16x16x32_bf16 v[4:7], v[212:215], v[188:191], v[4:7]
    ds_read_b128 v[204:207], v225 offset:2048
    v_subrev_u32 v225, 131072, v225
    v_mfma_f32_16x16x32_bf16 v[8:11], v[216:219], v[188:191], v[8:11]
    v_mfma_f32_16x16x32_bf16 v[12:15], v[220:223], v[188:191], v[12:15]
    ds_read_b64_tr_b16 v[188:189], v231
    s_waitcnt lgkmcnt(7)
    v_mfma_f32_16x16x32_bf16 v[32:35], v[192:195], v[176:179], v[32:35]
    ds_read_b64_tr_b16 v[190:191], v231 offset:1024
    v_mfma_f32_16x16x32_bf16 v[36:39], v[196:199], v[176:179], v[36:39]
    ds_read_b128 v[208:211], v226
    s_waitcnt lgkmcnt(6)
    v_mfma_f32_16x16x32_bf16 v[40:43], v[200:203], v[176:179], v[40:43]
    s_waitcnt lgkmcnt(3)
    v_mfma_f32_16x16x32_bf16 v[44:47], v[204:207], v[176:179], v[44:47]
    ds_read_b64_tr_b16 v[176:177], v228 offset:8192
    v_mfma_f32_16x16x32_bf16 v[48:51], v[192:195], v[180:183], v[48:51]
    ds_read_b64_tr_b16 v[178:179], v228 offset:9216
    v_subrev_u32 v228, 131072, v228
    v_mfma_f32_16x16x32_bf16 v[52:55], v[196:199], v[180:183], v[52:55]
    ds_read_b128 v[212:215], v226 offset:2048
    v_subrev_u32 v226, 131072, v226
    v_mfma_f32_16x16x32_bf16 v[56:59], v[200:203], v[180:183], v[56:59]
    v_mfma_f32_16x16x32_bf16 v[60:63], v[204:207], v[180:183], v[60:63]
    ds_read_b64_tr_b16 v[180:181], v229 offset:8192
    v_mfma_f32_16x16x32_bf16 v[64:67], v[192:195], v[184:187], v[64:67]
    ds_read_b64_tr_b16 v[182:183], v229 offset:9216
    v_subrev_u32 v229, 131072, v229
    v_mfma_f32_16x16x32_bf16 v[68:71], v[196:199], v[184:187], v[68:71]
    ds_read_b128 v[216:219], v227
    v_mfma_f32_16x16x32_bf16 v[72:75], v[200:203], v[184:187], v[72:75]
    v_mfma_f32_16x16x32_bf16 v[76:79], v[204:207], v[184:187], v[76:79]
    ds_read_b64_tr_b16 v[184:185], v230 offset:8192
    s_waitcnt lgkmcnt(7)
    v_mfma_f32_16x16x32_bf16 v[0:3], v[192:195], v[188:191], v[0:3]
    ds_read_b64_tr_b16 v[186:187], v230 offset:9216
    v_subrev_u32 v230, 131072, v230
    v_mfma_f32_16x16x32_bf16 v[4:7], v[196:199], v[188:191], v[4:7]
    ds_read_b128 v[220:223], v227 offset:2048
    v_subrev_u32 v227, 131072, v227
    v_mfma_f32_16x16x32_bf16 v[8:11], v[200:203], v[188:191], v[8:11]
    v_mfma_f32_16x16x32_bf16 v[12:15], v[204:207], v[188:191], v[12:15]
    ds_read_b64_tr_b16 v[188:189], v231 offset:8192
    s_waitcnt lgkmcnt(7)
    v_mfma_f32_16x16x32_bf16 v[32:35], v[208:211], v[176:179], v[32:35]
    ds_read_b64_tr_b16 v[190:191], v231 offset:9216
    v_subrev_u32 v231, 131072, v231
    s_barrier
    v_mfma_f32_16x16x32_bf16 v[36:39], v[212:215], v[176:179], v[36:39]
    ds_read_b128 v[192:195], v224
    s_waitcnt lgkmcnt(6)
    v_mfma_f32_16x16x32_bf16 v[40:43], v[216:219], v[176:179], v[40:43]
    s_waitcnt lgkmcnt(3)
    v_mfma_f32_16x16x32_bf16 v[44:47], v[220:223], v[176:179], v[44:47]
    ds_read_b64_tr_b16 v[176:177], v228
    v_mfma_f32_16x16x32_bf16 v[48:51], v[208:211], v[180:183], v[48:51]
    ds_read_b64_tr_b16 v[178:179], v228 offset:1024
    v_mfma_f32_16x16x32_bf16 v[52:55], v[212:215], v[180:183], v[52:55]
    ds_read_b128 v[196:199], v224 offset:2048
    v_mfma_f32_16x16x32_bf16 v[56:59], v[216:219], v[180:183], v[56:59]
    v_mfma_f32_16x16x32_bf16 v[60:63], v[220:223], v[180:183], v[60:63]
    ds_read_b64_tr_b16 v[180:181], v229
    v_mfma_f32_16x16x32_bf16 v[64:67], v[208:211], v[184:187], v[64:67]
    ds_read_b64_tr_b16 v[182:183], v229 offset:1024
    v_mfma_f32_16x16x32_bf16 v[68:71], v[212:215], v[184:187], v[68:71]
    ds_read_b128 v[200:203], v225
    v_mfma_f32_16x16x32_bf16 v[72:75], v[216:219], v[184:187], v[72:75]
    v_mfma_f32_16x16x32_bf16 v[76:79], v[220:223], v[184:187], v[76:79]
    ds_read_b64_tr_b16 v[184:185], v230
    s_waitcnt lgkmcnt(7)
    v_mfma_f32_16x16x32_bf16 v[0:3], v[208:211], v[188:191], v[0:3]
    ds_read_b64_tr_b16 v[186:187], v230 offset:1024
    v_mfma_f32_16x16x32_bf16 v[4:7], v[212:215], v[188:191], v[4:7]
    ds_read_b128 v[204:207], v225 offset:2048
    v_mfma_f32_16x16x32_bf16 v[8:11], v[216:219], v[188:191], v[8:11]
    v_mfma_f32_16x16x32_bf16 v[12:15], v[220:223], v[188:191], v[12:15]
    ds_read_b64_tr_b16 v[188:189], v231
    s_waitcnt lgkmcnt(8)
    v_mfma_f32_16x16x32_bf16 v[32:35], v[192:195], v[176:179], v[32:35]
    ds_read_b64_tr_b16 v[190:191], v231 offset:1024
    s_waitcnt lgkmcnt(8)
    v_mfma_f32_16x16x32_bf16 v[36:39], v[196:199], v[176:179], v[36:39]
    ds_read_b128 v[208:211], v226
    s_waitcnt lgkmcnt(6)
    v_mfma_f32_16x16x32_bf16 v[40:43], v[200:203], v[176:179], v[40:43]
    s_waitcnt lgkmcnt(3)
    v_mfma_f32_16x16x32_bf16 v[44:47], v[204:207], v[176:179], v[44:47]
    ds_read_b64_tr_b16 v[176:177], v228 offset:8192
    v_mfma_f32_16x16x32_bf16 v[48:51], v[192:195], v[180:183], v[48:51]
    ds_read_b64_tr_b16 v[178:179], v228 offset:9216
    v_mfma_f32_16x16x32_bf16 v[52:55], v[196:199], v[180:183], v[52:55]
    ds_read_b128 v[212:215], v226 offset:2048
    v_mfma_f32_16x16x32_bf16 v[56:59], v[200:203], v[180:183], v[56:59]
    v_mfma_f32_16x16x32_bf16 v[60:63], v[204:207], v[180:183], v[60:63]
    ds_read_b64_tr_b16 v[180:181], v229 offset:8192
    v_mfma_f32_16x16x32_bf16 v[64:67], v[192:195], v[184:187], v[64:67]
    ds_read_b64_tr_b16 v[182:183], v229 offset:9216
    v_mfma_f32_16x16x32_bf16 v[68:71], v[196:199], v[184:187], v[68:71]
    ds_read_b128 v[216:219], v227
    v_mfma_f32_16x16x32_bf16 v[72:75], v[200:203], v[184:187], v[72:75]
    v_mfma_f32_16x16x32_bf16 v[76:79], v[204:207], v[184:187], v[76:79]
    ds_read_b64_tr_b16 v[184:185], v230 offset:8192
    s_waitcnt lgkmcnt(7)
    v_mfma_f32_16x16x32_bf16 v[0:3], v[192:195], v[188:191], v[0:3]
    ds_read_b64_tr_b16 v[186:187], v230 offset:9216
    v_mfma_f32_16x16x32_bf16 v[4:7], v[196:199], v[188:191], v[4:7]
    ds_read_b128 v[220:223], v227 offset:2048
    v_mfma_f32_16x16x32_bf16 v[8:11], v[200:203], v[188:191], v[8:11]
    v_mfma_f32_16x16x32_bf16 v[12:15], v[204:207], v[188:191], v[12:15]
    ds_read_b64_tr_b16 v[188:189], v231 offset:8192
    s_waitcnt lgkmcnt(8)
    v_mfma_f32_16x16x32_bf16 v[32:35], v[208:211], v[176:179], v[32:35]
    ds_read_b64_tr_b16 v[190:191], v231 offset:9216
    s_waitcnt lgkmcnt(8)
    v_mfma_f32_16x16x32_bf16 v[36:39], v[212:215], v[176:179], v[36:39]
    s_waitcnt lgkmcnt(5)
    v_mfma_f32_16x16x32_bf16 v[40:43], v[216:219], v[176:179], v[40:43]
    s_waitcnt lgkmcnt(2)
    v_mfma_f32_16x16x32_bf16 v[44:47], v[220:223], v[176:179], v[44:47]
    v_mfma_f32_16x16x32_bf16 v[48:51], v[208:211], v[180:183], v[48:51]
    v_mfma_f32_16x16x32_bf16 v[52:55], v[212:215], v[180:183], v[52:55]
    v_mfma_f32_16x16x32_bf16 v[56:59], v[216:219], v[180:183], v[56:59]
    v_cvt_pk_bf16_f32 v32, v32, v33
    v_cvt_pk_bf16_f32 v33, v34, v35
    v_mfma_f32_16x16x32_bf16 v[60:63], v[220:223], v[180:183], v[60:63]
    v_cvt_pk_bf16_f32 v34, v36, v37
    v_cvt_pk_bf16_f32 v35, v38, v39
    v_mfma_f32_16x16x32_bf16 v[64:67], v[208:211], v[184:187], v[64:67]
    v_cvt_pk_bf16_f32 v40, v40, v41
    v_cvt_pk_bf16_f32 v41, v42, v43
    v_mfma_f32_16x16x32_bf16 v[68:71], v[212:215], v[184:187], v[68:71]
    v_cvt_pk_bf16_f32 v42, v44, v45
    v_cvt_pk_bf16_f32 v43, v46, v47
    v_mfma_f32_16x16x32_bf16 v[72:75], v[216:219], v[184:187], v[72:75]
    s_barrier
    ds_read_b128 v[192:195], v232
    v_cvt_pk_bf16_f32 v48, v48, v49
    v_cvt_pk_bf16_f32 v49, v50, v51
    v_mfma_f32_16x16x32_bf16 v[76:79], v[220:223], v[184:187], v[76:79]
    ds_read_b128 v[196:199], v232 offset:1024
    v_cvt_pk_bf16_f32 v50, v52, v53
    v_cvt_pk_bf16_f32 v51, v54, v55
    s_waitcnt lgkmcnt(2)
    v_mfma_f32_16x16x32_bf16 v[0:3], v[208:211], v[188:191], v[0:3]
    ds_read_b128 v[200:203], v232 offset:2048
    v_cvt_pk_bf16_f32 v56, v56, v57
    v_cvt_pk_bf16_f32 v57, v58, v59
    v_mfma_f32_16x16x32_bf16 v[4:7], v[212:215], v[188:191], v[4:7]
    ds_read_b128 v[204:207], v232 offset:3072
    v_cvt_pk_bf16_f32 v58, v60, v61
    v_cvt_pk_bf16_f32 v59, v62, v63
    v_mfma_f32_16x16x32_bf16 v[8:11], v[216:219], v[188:191], v[8:11]
    v_cvt_pk_bf16_f32 v64, v64, v65
    v_cvt_pk_bf16_f32 v65, v66, v67
    v_mfma_f32_16x16x32_bf16 v[12:15], v[220:223], v[188:191], v[12:15]
    v_cvt_pk_bf16_f32 v66, v68, v69
    v_cvt_pk_bf16_f32 v67, v70, v71
    ds_read_b128 v[208:211], v232 offset:4096
    ds_read_b128 v[216:219], v232 offset:6144
    ds_read_b128 v[212:215], v232 offset:5120
    ds_read_b128 v[220:223], v232 offset:7168
    s_waitcnt lgkmcnt(6)
    v_mfma_f32_16x16x32_bf16 v[16:19], v[80:83], v[192:195], 0
    v_cvt_pk_bf16_f32 v72, v72, v73
    v_cvt_pk_bf16_f32 v73, v74, v75
    v_mfma_f32_16x16x32_bf16 v[20:23], v[84:87], v[192:195], 0
    v_cvt_pk_bf16_f32 v74, v76, v77
    v_cvt_pk_bf16_f32 v75, v78, v79
    s_waitcnt lgkmcnt(4)
    v_mfma_f32_16x16x32_bf16 v[16:19], v[88:91], v[200:203], v[16:19]
    v_cvt_pk_bf16_f32 v0, v0, v1
    v_cvt_pk_bf16_f32 v1, v2, v3
    v_mfma_f32_16x16x32_bf16 v[20:23], v[92:95], v[200:203], v[20:23]
    v_cvt_pk_bf16_f32 v2, v4, v5
    v_cvt_pk_bf16_f32 v3, v6, v7
    s_waitcnt lgkmcnt(3)
    v_mfma_f32_16x16x32_bf16 v[16:19], v[96:99], v[208:211], v[16:19]
    v_cvt_pk_bf16_f32 v8, v8, v9
    v_cvt_pk_bf16_f32 v9, v10, v11
    v_mfma_f32_16x16x32_bf16 v[20:23], v[100:103], v[208:211], v[20:23]
    v_cvt_pk_bf16_f32 v10, v12, v13
    v_cvt_pk_bf16_f32 v11, v14, v15
    s_waitcnt lgkmcnt(0)
    v_mfma_f32_16x16x32_bf16 v[16:19], v[32:35], v[216:219], v[16:19]
    v_mfma_f32_16x16x32_bf16 v[20:23], v[48:51], v[216:219], v[20:23]
    v_mfma_f32_16x16x32_bf16 v[24:27], v[80:83], v[196:199], 0
    ds_read_b128 v[36:39], v233
    v_mfma_f32_16x16x32_bf16 v[28:31], v[84:87], v[196:199], 0
    ds_read_b128 v[44:47], v233 offset:1024
    v_mfma_f32_16x16x32_bf16 v[24:27], v[88:91], v[204:207], v[24:27]
    ds_read_b128 v[52:55], v233 offset:2048
    s_nop 0
    v_cvt_pk_bf16_f32 v16, v16, v17
    v_cvt_pk_bf16_f32 v17, v18, v19
    v_cvt_pk_bf16_f32 v18, v20, v21
    v_cvt_pk_bf16_f32 v19, v22, v23
    buffer_store_dwordx4 v[16:19], v238, s[44:47], s28 offen offset:0 sc1
    buffer_store_dword v241, v237, s[44:47], s63 offen sc1
    v_mfma_f32_16x16x32_bf16 v[28:31], v[92:95], v[204:207], v[28:31]
    ds_read_b128 v[60:63], v233 offset:3072
    v_mfma_f32_16x16x32_bf16 v[24:27], v[96:99], v[212:215], v[24:27]
    ds_read_b128 v[68:71], v233 offset:4096
    v_mfma_f32_16x16x32_bf16 v[28:31], v[100:103], v[212:215], v[28:31]
    ds_read_b128 v[76:79], v233 offset:5120
    v_mfma_f32_16x16x32_bf16 v[24:27], v[32:35], v[220:223], v[24:27]
    ds_read_b128 v[4:7], v233 offset:6144
    v_mfma_f32_16x16x32_bf16 v[28:31], v[48:51], v[220:223], v[28:31]
    ds_read_b128 v[12:15], v233 offset:7168
    v_mfma_f32_16x16x32_bf16 v[176:179], v[104:107], v[192:195], 0
    v_mfma_f32_16x16x32_bf16 v[180:183], v[108:111], v[192:195], 0
    v_mfma_f32_16x16x32_bf16 v[176:179], v[112:115], v[200:203], v[176:179]
    s_nop 1
    v_cvt_pk_bf16_f32 v20, v24, v25
    v_cvt_pk_bf16_f32 v21, v26, v27
    v_cvt_pk_bf16_f32 v22, v28, v29
    v_cvt_pk_bf16_f32 v23, v30, v31
    buffer_store_dwordx4 v[20:23], v238, s[44:47], s28 offen offset:1024 sc1
    v_mfma_f32_16x16x32_bf16 v[180:183], v[116:119], v[200:203], v[180:183]
    v_mfma_f32_16x16x32_bf16 v[176:179], v[120:123], v[208:211], v[176:179]
    v_mfma_f32_16x16x32_bf16 v[180:183], v[124:127], v[208:211], v[180:183]
    v_bitop3_b32 v24, v16, v17, v18 bitop3:0x96
    v_bitop3_b32 v25, v19, v20, v21 bitop3:0x96
    v_bitop3_b32 v26, v22, v23, v241 bitop3:0x96
    v_bitop3_b32 v24, v24, v25, v26 bitop3:0x96
    buffer_store_dword v24, v242, s[44:47], s28 offen offset:2048 sc1
    v_mfma_f32_16x16x32_bf16 v[176:179], v[64:67], v[216:219], v[176:179]
    v_mfma_f32_16x16x32_bf16 v[180:183], v[0:3], v[216:219], v[180:183]
    v_mfma_f32_16x16x32_bf16 v[184:187], v[104:107], v[196:199], 0
    v_mfma_f32_16x16x32_bf16 v[188:191], v[108:111], v[196:199], 0
    v_mfma_f32_16x16x32_bf16 v[184:187], v[112:115], v[204:207], v[184:187]
    s_nop 3
    v_cvt_pk_bf16_f32 v176, v176, v177
    v_cvt_pk_bf16_f32 v177, v178, v179
    v_cvt_pk_bf16_f32 v178, v180, v181
    v_cvt_pk_bf16_f32 v179, v182, v183
    buffer_store_dwordx4 v[176:179], v238, s[44:47], s30 offen offset:0 sc1
    buffer_store_dword v241, v237, s[44:47], s64 offen sc1
    v_mfma_f32_16x16x32_bf16 v[188:191], v[116:119], v[204:207], v[188:191]
    v_mfma_f32_16x16x32_bf16 v[184:187], v[120:123], v[212:215], v[184:187]
    v_mfma_f32_16x16x32_bf16 v[188:191], v[124:127], v[212:215], v[188:191]
    v_mfma_f32_16x16x32_bf16 v[184:187], v[64:67], v[220:223], v[184:187]
    v_mfma_f32_16x16x32_bf16 v[188:191], v[0:3], v[220:223], v[188:191]
    s_waitcnt lgkmcnt(0)
    v_mfma_f32_16x16x32_bf16 v[80:83], v[128:131], v[36:39], 0
    v_mfma_f32_16x16x32_bf16 v[84:87], v[132:135], v[36:39], 0
    v_mfma_f32_16x16x32_bf16 v[80:83], v[136:139], v[52:55], v[80:83]
    s_nop 2
    v_cvt_pk_bf16_f32 v180, v184, v185
    v_cvt_pk_bf16_f32 v181, v186, v187
    v_cvt_pk_bf16_f32 v182, v188, v189
    v_cvt_pk_bf16_f32 v183, v190, v191
    buffer_store_dwordx4 v[180:183], v238, s[44:47], s30 offen offset:1024 sc1
    v_mfma_f32_16x16x32_bf16 v[84:87], v[140:143], v[52:55], v[84:87]
    v_mfma_f32_16x16x32_bf16 v[80:83], v[144:147], v[68:71], v[80:83]
    v_mfma_f32_16x16x32_bf16 v[84:87], v[148:151], v[68:71], v[84:87]
    v_bitop3_b32 v184, v176, v177, v178 bitop3:0x96
    v_bitop3_b32 v185, v179, v180, v181 bitop3:0x96
    v_bitop3_b32 v186, v182, v183, v241 bitop3:0x96
    v_bitop3_b32 v184, v184, v185, v186 bitop3:0x96
    buffer_store_dword v184, v242, s[44:47], s30 offen offset:2048 sc1
    v_mfma_f32_16x16x32_bf16 v[80:83], v[40:43], v[4:7], v[80:83]
    v_mfma_f32_16x16x32_bf16 v[84:87], v[56:59], v[4:7], v[84:87]
    v_mfma_f32_16x16x32_bf16 v[88:91], v[128:131], v[44:47], 0
    v_mfma_f32_16x16x32_bf16 v[92:95], v[132:135], v[44:47], 0
    v_mfma_f32_16x16x32_bf16 v[88:91], v[136:139], v[60:63], v[88:91]
    s_nop 3
    v_cvt_pk_bf16_f32 v80, v80, v81
    v_cvt_pk_bf16_f32 v81, v82, v83
    v_cvt_pk_bf16_f32 v82, v84, v85
    v_cvt_pk_bf16_f32 v83, v86, v87
    buffer_store_dwordx4 v[80:83], v238, s[44:47], s31 offen offset:0 sc1
    buffer_store_dword v241, v237, s[44:47], s65 offen sc1
    v_mfma_f32_16x16x32_bf16 v[92:95], v[140:143], v[60:63], v[92:95]
    v_mfma_f32_16x16x32_bf16 v[88:91], v[144:147], v[76:79], v[88:91]
    v_mfma_f32_16x16x32_bf16 v[92:95], v[148:151], v[76:79], v[92:95]
    v_mfma_f32_16x16x32_bf16 v[88:91], v[40:43], v[12:15], v[88:91]
    v_mfma_f32_16x16x32_bf16 v[92:95], v[56:59], v[12:15], v[92:95]
    v_mfma_f32_16x16x32_bf16 v[104:107], v[152:155], v[36:39], 0
    v_mfma_f32_16x16x32_bf16 v[108:111], v[156:159], v[36:39], 0
    v_mfma_f32_16x16x32_bf16 v[104:107], v[160:163], v[52:55], v[104:107]
    s_nop 3
    v_cvt_pk_bf16_f32 v84, v88, v89
    v_cvt_pk_bf16_f32 v85, v90, v91
    v_cvt_pk_bf16_f32 v86, v92, v93
    v_cvt_pk_bf16_f32 v87, v94, v95
    buffer_store_dwordx4 v[84:87], v238, s[44:47], s31 offen offset:1024 sc1
    v_mfma_f32_16x16x32_bf16 v[108:111], v[164:167], v[52:55], v[108:111]
    v_mfma_f32_16x16x32_bf16 v[104:107], v[168:171], v[68:71], v[104:107]
    v_mfma_f32_16x16x32_bf16 v[108:111], v[172:175], v[68:71], v[108:111]
    v_bitop3_b32 v88, v80, v81, v82 bitop3:0x96
    v_bitop3_b32 v89, v83, v84, v85 bitop3:0x96
    v_bitop3_b32 v90, v86, v87, v241 bitop3:0x96
    v_bitop3_b32 v88, v88, v89, v90 bitop3:0x96
    buffer_store_dword v88, v242, s[44:47], s31 offen offset:2048 sc1
    v_mfma_f32_16x16x32_bf16 v[104:107], v[72:75], v[4:7], v[104:107]
    v_mfma_f32_16x16x32_bf16 v[108:111], v[8:11], v[4:7], v[108:111]
    v_mfma_f32_16x16x32_bf16 v[112:115], v[152:155], v[44:47], 0
    v_mfma_f32_16x16x32_bf16 v[116:119], v[156:159], v[44:47], 0
    v_mfma_f32_16x16x32_bf16 v[112:115], v[160:163], v[60:63], v[112:115]
    v_mfma_f32_16x16x32_bf16 v[116:119], v[164:167], v[60:63], v[116:119]
    v_mfma_f32_16x16x32_bf16 v[112:115], v[168:171], v[76:79], v[112:115]
    v_mfma_f32_16x16x32_bf16 v[116:119], v[172:175], v[76:79], v[116:119]
    v_mfma_f32_16x16x32_bf16 v[112:115], v[72:75], v[12:15], v[112:115]
    v_mfma_f32_16x16x32_bf16 v[116:119], v[8:11], v[12:15], v[116:119]
    ds_write_b128 v240, v[104:107]
    ds_write_b128 v240, v[108:111] offset:1024
    s_nop 4
    ds_write_b128 v240, v[112:115] offset:2048
    ds_write_b128 v240, v[116:119] offset:3072
    s_waitcnt lgkmcnt(0)
    s_barrier
    s_endpgm
.p2align 12
.fill 128, 4, 0xbf800000
L_Ucomp3:
    s_barrier
    ds_read_b128 v[192:195], v224
    ds_read_b128 v[196:199], v224 offset:2048
    ds_read_b128 v[200:203], v225
    ds_read_b128 v[204:207], v225 offset:2048
    ds_read_b64_tr_b16 v[176:177], v228
    ds_read_b64_tr_b16 v[178:179], v228 offset:1024
    ds_read_b64_tr_b16 v[180:181], v229
    ds_read_b64_tr_b16 v[182:183], v229 offset:1024
    s_waitcnt lgkmcnt(2)
    v_mfma_f32_16x16x32_bf16 v[0:3], v[192:195], v[176:179], 0
    v_mfma_f32_16x16x32_bf16 v[4:7], v[196:199], v[176:179], 0
    ds_read_b128 v[208:211], v226
    v_mfma_f32_16x16x32_bf16 v[8:11], v[200:203], v[176:179], 0
    ds_read_b128 v[212:215], v226 offset:2048
    v_mfma_f32_16x16x32_bf16 v[12:15], v[204:207], v[176:179], 0
    ds_read_b64_tr_b16 v[176:177], v228 offset:8192
    s_waitcnt lgkmcnt(3)
    v_mfma_f32_16x16x32_bf16 v[16:19], v[192:195], v[180:183], 0
    ds_read_b64_tr_b16 v[178:179], v228 offset:9216
    v_mfma_f32_16x16x32_bf16 v[20:23], v[196:199], v[180:183], 0
    ds_read_b128 v[216:219], v227
    v_mfma_f32_16x16x32_bf16 v[24:27], v[200:203], v[180:183], 0
    ds_read_b128 v[220:223], v227 offset:2048
    v_mfma_f32_16x16x32_bf16 v[28:31], v[204:207], v[180:183], 0
    ds_read_b64_tr_b16 v[180:181], v229 offset:8192
    s_waitcnt lgkmcnt(3)
    v_mfma_f32_16x16x32_bf16 v[0:3], v[208:211], v[176:179], v[0:3]
    ds_read_b64_tr_b16 v[182:183], v229 offset:9216
    s_barrier
    v_mfma_f32_16x16x32_bf16 v[4:7], v[212:215], v[176:179], v[4:7]
    ds_read_b128 v[192:195], v224 offset:32768
    s_waitcnt lgkmcnt(4)
    v_mfma_f32_16x16x32_bf16 v[8:11], v[216:219], v[176:179], v[8:11]
    ds_read_b128 v[196:199], v224 offset:34816
    v_add_u32 v224, 65536, v224
    s_waitcnt lgkmcnt(4)
    v_mfma_f32_16x16x32_bf16 v[12:15], v[220:223], v[176:179], v[12:15]
    ds_read_b64_tr_b16 v[176:177], v228 offset:32768
    s_waitcnt lgkmcnt(3)
    v_mfma_f32_16x16x32_bf16 v[16:19], v[208:211], v[180:183], v[16:19]
    ds_read_b64_tr_b16 v[178:179], v228 offset:33792
    v_mfma_f32_16x16x32_bf16 v[20:23], v[212:215], v[180:183], v[20:23]
    ds_read_b128 v[200:203], v225 offset:32768
    v_mfma_f32_16x16x32_bf16 v[24:27], v[216:219], v[180:183], v[24:27]
    ds_read_b128 v[204:207], v225 offset:34816
    v_add_u32 v225, 65536, v225
    v_mfma_f32_16x16x32_bf16 v[28:31], v[220:223], v[180:183], v[28:31]
    ds_read_b64_tr_b16 v[180:181], v229 offset:32768
    s_waitcnt lgkmcnt(3)
    v_mfma_f32_16x16x32_bf16 v[0:3], v[192:195], v[176:179], v[0:3]
    ds_read_b64_tr_b16 v[182:183], v229 offset:33792
    v_mfma_f32_16x16x32_bf16 v[4:7], v[196:199], v[176:179], v[4:7]
    ds_read_b128 v[208:211], v226 offset:32768
    s_waitcnt lgkmcnt(4)
    v_mfma_f32_16x16x32_bf16 v[8:11], v[200:203], v[176:179], v[8:11]
    ds_read_b128 v[212:215], v226 offset:34816
    v_add_u32 v226, 65536, v226
    s_waitcnt lgkmcnt(4)
    v_mfma_f32_16x16x32_bf16 v[12:15], v[204:207], v[176:179], v[12:15]
    ds_read_b64_tr_b16 v[176:177], v228 offset:40960
    s_waitcnt lgkmcnt(3)
    v_mfma_f32_16x16x32_bf16 v[16:19], v[192:195], v[180:183], v[16:19]
    ds_read_b64_tr_b16 v[178:179], v228 offset:41984
    v_add_u32 v228, 65536, v228
    v_mfma_f32_16x16x32_bf16 v[20:23], v[196:199], v[180:183], v[20:23]
    ds_read_b128 v[216:219], v227 offset:32768
    v_mfma_f32_16x16x32_bf16 v[24:27], v[200:203], v[180:183], v[24:27]
    ds_read_b128 v[220:223], v227 offset:34816
    v_add_u32 v227, 65536, v227
    v_mfma_f32_16x16x32_bf16 v[28:31], v[204:207], v[180:183], v[28:31]
    ds_read_b64_tr_b16 v[180:181], v229 offset:40960
    s_waitcnt lgkmcnt(3)
    v_mfma_f32_16x16x32_bf16 v[0:3], v[208:211], v[176:179], v[0:3]
    ds_read_b64_tr_b16 v[182:183], v229 offset:41984
    v_add_u32 v229, 65536, v229
    s_barrier
    buffer_load_dword v236, v237, s[48:51], 0 offen sc1
    v_mfma_f32_16x16x32_bf16 v[4:7], v[212:215], v[176:179], v[4:7]
    ds_read_b128 v[192:195], v224
    s_waitcnt lgkmcnt(4)
    v_mfma_f32_16x16x32_bf16 v[8:11], v[216:219], v[176:179], v[8:11]
    ds_read_b128 v[196:199], v224 offset:2048
    s_waitcnt lgkmcnt(4)
    v_mfma_f32_16x16x32_bf16 v[12:15], v[220:223], v[176:179], v[12:15]
    ds_read_b64_tr_b16 v[176:177], v228
    s_waitcnt lgkmcnt(3)
    v_mfma_f32_16x16x32_bf16 v[16:19], v[208:211], v[180:183], v[16:19]
    ds_read_b64_tr_b16 v[178:179], v228 offset:1024
    v_mfma_f32_16x16x32_bf16 v[20:23], v[212:215], v[180:183], v[20:23]
    ds_read_b128 v[200:203], v225
    v_mfma_f32_16x16x32_bf16 v[24:27], v[216:219], v[180:183], v[24:27]
    ds_read_b128 v[204:207], v225 offset:2048
    v_mfma_f32_16x16x32_bf16 v[28:31], v[220:223], v[180:183], v[28:31]
    ds_read_b64_tr_b16 v[180:181], v229
    s_waitcnt lgkmcnt(3)
    v_mfma_f32_16x16x32_bf16 v[0:3], v[192:195], v[176:179], v[0:3]
    ds_read_b64_tr_b16 v[182:183], v229 offset:1024
    v_mfma_f32_16x16x32_bf16 v[4:7], v[196:199], v[176:179], v[4:7]
    ds_read_b128 v[208:211], v226
    s_waitcnt lgkmcnt(4)
    v_mfma_f32_16x16x32_bf16 v[8:11], v[200:203], v[176:179], v[8:11]
    ds_read_b128 v[212:215], v226 offset:2048
    s_waitcnt lgkmcnt(4)
    v_mfma_f32_16x16x32_bf16 v[12:15], v[204:207], v[176:179], v[12:15]
    ds_read_b64_tr_b16 v[176:177], v228 offset:8192
    s_waitcnt lgkmcnt(3)
    v_mfma_f32_16x16x32_bf16 v[16:19], v[192:195], v[180:183], v[16:19]
    ds_read_b64_tr_b16 v[178:179], v228 offset:9216
    v_mfma_f32_16x16x32_bf16 v[20:23], v[196:199], v[180:183], v[20:23]
    ds_read_b128 v[216:219], v227
    v_mfma_f32_16x16x32_bf16 v[24:27], v[200:203], v[180:183], v[24:27]
    ds_read_b128 v[220:223], v227 offset:2048
    v_mfma_f32_16x16x32_bf16 v[28:31], v[204:207], v[180:183], v[28:31]
    ds_read_b64_tr_b16 v[180:181], v229 offset:8192
    s_waitcnt lgkmcnt(3)
    v_mfma_f32_16x16x32_bf16 v[0:3], v[208:211], v[176:179], v[0:3]
    ds_read_b64_tr_b16 v[182:183], v229 offset:9216
    s_barrier
    v_mfma_f32_16x16x32_bf16 v[4:7], v[212:215], v[176:179], v[4:7]
    ds_read_b128 v[192:195], v224 offset:32768
    s_waitcnt lgkmcnt(4)
    v_mfma_f32_16x16x32_bf16 v[8:11], v[216:219], v[176:179], v[8:11]
    ds_read_b128 v[196:199], v224 offset:34816
    v_add_u32 v224, 65536, v224
    s_waitcnt lgkmcnt(4)
    v_mfma_f32_16x16x32_bf16 v[12:15], v[220:223], v[176:179], v[12:15]
    ds_read_b64_tr_b16 v[176:177], v228 offset:32768
    s_waitcnt lgkmcnt(3)
    v_mfma_f32_16x16x32_bf16 v[16:19], v[208:211], v[180:183], v[16:19]
    ds_read_b64_tr_b16 v[178:179], v228 offset:33792
    v_mfma_f32_16x16x32_bf16 v[20:23], v[212:215], v[180:183], v[20:23]
    ds_read_b128 v[200:203], v225 offset:32768
    v_mfma_f32_16x16x32_bf16 v[24:27], v[216:219], v[180:183], v[24:27]
    ds_read_b128 v[204:207], v225 offset:34816
    v_add_u32 v225, 65536, v225
    v_mfma_f32_16x16x32_bf16 v[28:31], v[220:223], v[180:183], v[28:31]
    ds_read_b64_tr_b16 v[180:181], v229 offset:32768
    s_waitcnt lgkmcnt(3)
    v_mfma_f32_16x16x32_bf16 v[0:3], v[192:195], v[176:179], v[0:3]
    ds_read_b64_tr_b16 v[182:183], v229 offset:33792
    v_mfma_f32_16x16x32_bf16 v[4:7], v[196:199], v[176:179], v[4:7]
    ds_read_b128 v[208:211], v226 offset:32768
    s_waitcnt lgkmcnt(4)
    v_mfma_f32_16x16x32_bf16 v[8:11], v[200:203], v[176:179], v[8:11]
    ds_read_b128 v[212:215], v226 offset:34816
    v_add_u32 v226, 65536, v226
    s_waitcnt lgkmcnt(4)
    v_mfma_f32_16x16x32_bf16 v[12:15], v[204:207], v[176:179], v[12:15]
    ds_read_b64_tr_b16 v[176:177], v228 offset:40960
    s_waitcnt lgkmcnt(3)
    v_mfma_f32_16x16x32_bf16 v[16:19], v[192:195], v[180:183], v[16:19]
    ds_read_b64_tr_b16 v[178:179], v228 offset:41984
    v_add_u32 v228, 65536, v228
    v_mfma_f32_16x16x32_bf16 v[20:23], v[196:199], v[180:183], v[20:23]
    ds_read_b128 v[216:219], v227 offset:32768
    v_mfma_f32_16x16x32_bf16 v[24:27], v[200:203], v[180:183], v[24:27]
    ds_read_b128 v[220:223], v227 offset:34816
    v_add_u32 v227, 65536, v227
    v_mfma_f32_16x16x32_bf16 v[28:31], v[204:207], v[180:183], v[28:31]
    ds_read_b64_tr_b16 v[180:181], v229 offset:40960
    s_waitcnt lgkmcnt(3)
    v_mfma_f32_16x16x32_bf16 v[0:3], v[208:211], v[176:179], v[0:3]
    ds_read_b64_tr_b16 v[182:183], v229 offset:41984
    v_add_u32 v229, 65536, v229
    s_waitcnt vmcnt(0)
    s_mov_b32 s62, 524288
L_ep11:
    v_readfirstlane_b32 s61, v236
    s_nop 1
    s_cmp_lg_u32 s61, 0
    s_cbranch_scc1 L_ep11_ok
    s_sub_u32 s62, s62, 1
    s_cbranch_scc1 L_ep11_ok
    buffer_load_dword v236, v237, s[48:51], 0 offen sc1
    s_waitcnt vmcnt(0)
    s_branch L_ep11
L_ep11_ok:
    s_nop 1
    v_mov_b32 v241, s61
    s_barrier
    v_mfma_f32_16x16x32_bf16 v[4:7], v[212:215], v[176:179], v[4:7]
    ds_read_b128 v[192:195], v224
    s_waitcnt lgkmcnt(2)
    v_mfma_f32_16x16x32_bf16 v[8:11], v[216:219], v[176:179], v[8:11]
    ds_read_b128 v[196:199], v224 offset:2048
    v_subrev_u32 v224, 131072, v224
    v_mfma_f32_16x16x32_bf16 v[12:15], v[220:223], v[176:179], v[12:15]
    ds_read_b64_tr_b16 v[176:177], v228
    s_waitcnt lgkmcnt(3)
    v_mfma_f32_16x16x32_bf16 v[16:19], v[208:211], v[180:183], v[16:19]
    ds_read_b64_tr_b16 v[178:179], v228 offset:1024
    v_mfma_f32_16x16x32_bf16 v[20:23], v[212:215], v[180:183], v[20:23]
    ds_read_b128 v[200:203], v225
    v_mfma_f32_16x16x32_bf16 v[24:27], v[216:219], v[180:183], v[24:27]
    ds_read_b128 v[204:207], v225 offset:2048
    v_subrev_u32 v225, 131072, v225
    v_mfma_f32_16x16x32_bf16 v[28:31], v[220:223], v[180:183], v[28:31]
    ds_read_b64_tr_b16 v[180:181], v229
    s_waitcnt lgkmcnt(3)
    v_mfma_f32_16x16x32_bf16 v[32:35], v[192:195], v[176:179], 0
    ds_read_b64_tr_b16 v[182:183], v229 offset:1024
    v_mfma_f32_16x16x32_bf16 v[36:39], v[196:199], v[176:179], 0
    ds_read_b128 v[208:211], v226
    s_waitcnt lgkmcnt(4)
    v_mfma_f32_16x16x32_bf16 v[40:43], v[200:203], v[176:179], 0
    ds_read_b128 v[212:215], v226 offset:2048
    v_subrev_u32 v226, 131072, v226
    s_waitcnt lgkmcnt(4)
    v_mfma_f32_16x16x32_bf16 v[44:47], v[204:207], v[176:179], 0
    ds_read_b64_tr_b16 v[176:177], v228 offset:8192
    s_waitcnt lgkmcnt(3)
    v_mfma_f32_16x16x32_bf16 v[48:51], v[192:195], v[180:183], 0
    ds_read_b64_tr_b16 v[178:179], v228 offset:9216
    v_subrev_u32 v228, 131072, v228
    v_mfma_f32_16x16x32_bf16 v[52:55], v[196:199], v[180:183], 0
    ds_read_b128 v[216:219], v227
    v_mfma_f32_16x16x32_bf16 v[56:59], v[200:203], v[180:183], 0
    ds_read_b128 v[220:223], v227 offset:2048
    v_subrev_u32 v227, 131072, v227
    v_mfma_f32_16x16x32_bf16 v[60:63], v[204:207], v[180:183], 0
    ds_read_b64_tr_b16 v[180:181], v229 offset:8192
    s_waitcnt lgkmcnt(3)
    v_mfma_f32_16x16x32_bf16 v[32:35], v[208:211], v[176:179], v[32:35]
    ds_read_b64_tr_b16 v[182:183], v229 offset:9216
    v_subrev_u32 v229, 131072, v229
    s_barrier
    v_cvt_pk_bf16_f32 v80, v0, v1
    v_cvt_pk_bf16_f32 v81, v2, v3
    v_mfma_f32_16x16x32_bf16 v[36:39], v[212:215], v[176:179], v[36:39]
    ds_read_b128 v[192:195], v224
    v_cvt_pk_bf16_f32 v82, v4, v5
    v_cvt_pk_bf16_f32 v83, v6, v7
    s_waitcnt lgkmcnt(4)
    v_mfma_f32_16x16x32_bf16 v[40:43], v[216:219], v[176:179], v[40:43]
    ds_read_b128 v[196:199], v224 offset:2048
    v_cvt_pk_bf16_f32 v112, v8, v9
    v_cvt_pk_bf16_f32 v113, v10, v11
    s_waitcnt lgkmcnt(4)
    v_mfma_f32_16x16x32_bf16 v[44:47], v[220:223], v[176:179], v[44:47]
    ds_read_b64_tr_b16 v[176:177], v228
    v_cvt_pk_bf16_f32 v114, v12, v13
    v_cvt_pk_bf16_f32 v115, v14, v15
    s_waitcnt lgkmcnt(3)
    v_mfma_f32_16x16x32_bf16 v[48:51], v[208:211], v[180:183], v[48:51]
    ds_read_b64_tr_b16 v[178:179], v228 offset:1024
    v_cvt_pk_bf16_f32 v84, v16, v17
    v_cvt_pk_bf16_f32 v85, v18, v19
    v_mfma_f32_16x16x32_bf16 v[52:55], v[212:215], v[180:183], v[52:55]
    ds_read_b128 v[200:203], v225
    v_cvt_pk_bf16_f32 v86, v20, v21
    v_cvt_pk_bf16_f32 v87, v22, v23
    v_mfma_f32_16x16x32_bf16 v[56:59], v[216:219], v[180:183], v[56:59]
    ds_read_b128 v[204:207], v225 offset:2048
    v_cvt_pk_bf16_f32 v116, v24, v25
    v_cvt_pk_bf16_f32 v117, v26, v27
    v_mfma_f32_16x16x32_bf16 v[60:63], v[220:223], v[180:183], v[60:63]
    ds_read_b64_tr_b16 v[180:181], v229
    v_cvt_pk_bf16_f32 v118, v28, v29
    v_cvt_pk_bf16_f32 v119, v30, v31
    s_waitcnt lgkmcnt(3)
    v_mfma_f32_16x16x32_bf16 v[32:35], v[192:195], v[176:179], v[32:35]
    ds_read_b64_tr_b16 v[182:183], v229 offset:1024
    v_mfma_f32_16x16x32_bf16 v[36:39], v[196:199], v[176:179], v[36:39]
    ds_read_b128 v[208:211], v226
    s_waitcnt lgkmcnt(4)
    v_mfma_f32_16x16x32_bf16 v[40:43], v[200:203], v[176:179], v[40:43]
    ds_read_b128 v[212:215], v226 offset:2048
    s_waitcnt lgkmcnt(4)
    v_mfma_f32_16x16x32_bf16 v[44:47], v[204:207], v[176:179], v[44:47]
    ds_read_b64_tr_b16 v[176:177], v228 offset:8192
    s_waitcnt lgkmcnt(3)
    v_mfma_f32_16x16x32_bf16 v[48:51], v[192:195], v[180:183], v[48:51]
    ds_read_b64_tr_b16 v[178:179], v228 offset:9216
    v_mfma_f32_16x16x32_bf16 v[52:55], v[196:199], v[180:183], v[52:55]
    ds_read_b128 v[216:219], v227
    v_mfma_f32_16x16x32_bf16 v[56:59], v[200:203], v[180:183], v[56:59]
    ds_read_b128 v[220:223], v227 offset:2048
    v_mfma_f32_16x16x32_bf16 v[60:63], v[204:207], v[180:183], v[60:63]
    ds_read_b64_tr_b16 v[180:181], v229 offset:8192
    s_waitcnt lgkmcnt(3)
    v_mfma_f32_16x16x32_bf16 v[32:35], v[208:211], v[176:179], v[32:35]
    ds_read_b64_tr_b16 v[182:183], v229 offset:9216
    s_barrier
    v_mfma_f32_16x16x32_bf16 v[36:39], v[212:215], v[176:179], v[36:39]
    ds_read_b128 v[192:195], v224 offset:32768
    s_waitcnt lgkmcnt(4)
    v_mfma_f32_16x16x32_bf16 v[40:43], v[216:219], v[176:179], v[40:43]
    ds_read_b128 v[196:199], v224 offset:34816
    v_add_u32 v224, 65536, v224
    s_waitcnt lgkmcnt(4)
    v_mfma_f32_16x16x32_bf16 v[44:47], v[220:223], v[176:179], v[44:47]
    ds_read_b64_tr_b16 v[176:177], v228 offset:32768
    s_waitcnt lgkmcnt(3)
    v_mfma_f32_16x16x32_bf16 v[48:51], v[208:211], v[180:183], v[48:51]
    ds_read_b64_tr_b16 v[178:179], v228 offset:33792
    v_mfma_f32_16x16x32_bf16 v[52:55], v[212:215], v[180:183], v[52:55]
    ds_read_b128 v[200:203], v225 offset:32768
    v_mfma_f32_16x16x32_bf16 v[56:59], v[216:219], v[180:183], v[56:59]
    ds_read_b128 v[204:207], v225 offset:34816
    v_add_u32 v225, 65536, v225
    v_mfma_f32_16x16x32_bf16 v[60:63], v[220:223], v[180:183], v[60:63]
    ds_read_b64_tr_b16 v[180:181], v229 offset:32768
    s_waitcnt lgkmcnt(3)
    v_mfma_f32_16x16x32_bf16 v[32:35], v[192:195], v[176:179], v[32:35]
    ds_read_b64_tr_b16 v[182:183], v229 offset:33792
    v_mfma_f32_16x16x32_bf16 v[36:39], v[196:199], v[176:179], v[36:39]
    ds_read_b128 v[208:211], v226 offset:32768
    s_waitcnt lgkmcnt(4)
    v_mfma_f32_16x16x32_bf16 v[40:43], v[200:203], v[176:179], v[40:43]
    ds_read_b128 v[212:215], v226 offset:34816
    v_add_u32 v226, 65536, v226
    s_waitcnt lgkmcnt(4)
    v_mfma_f32_16x16x32_bf16 v[44:47], v[204:207], v[176:179], v[44:47]
    ds_read_b64_tr_b16 v[176:177], v228 offset:40960
    s_waitcnt lgkmcnt(3)
    v_mfma_f32_16x16x32_bf16 v[48:51], v[192:195], v[180:183], v[48:51]
    ds_read_b64_tr_b16 v[178:179], v228 offset:41984
    v_add_u32 v228, 65536, v228
    v_mfma_f32_16x16x32_bf16 v[52:55], v[196:199], v[180:183], v[52:55]
    ds_read_b128 v[216:219], v227 offset:32768
    v_mfma_f32_16x16x32_bf16 v[56:59], v[200:203], v[180:183], v[56:59]
    ds_read_b128 v[220:223], v227 offset:34816
    v_add_u32 v227, 65536, v227
    v_mfma_f32_16x16x32_bf16 v[60:63], v[204:207], v[180:183], v[60:63]
    ds_read_b64_tr_b16 v[180:181], v229 offset:40960
    s_waitcnt lgkmcnt(3)
    v_mfma_f32_16x16x32_bf16 v[32:35], v[208:211], v[176:179], v[32:35]
    ds_read_b64_tr_b16 v[182:183], v229 offset:41984
    v_add_u32 v229, 65536, v229
    s_barrier
    v_mfma_f32_16x16x32_bf16 v[36:39], v[212:215], v[176:179], v[36:39]
    ds_read_b128 v[192:195], v224
    s_waitcnt lgkmcnt(4)
    v_mfma_f32_16x16x32_bf16 v[40:43], v[216:219], v[176:179], v[40:43]
    ds_read_b128 v[196:199], v224 offset:2048
    s_waitcnt lgkmcnt(4)
    v_mfma_f32_16x16x32_bf16 v[44:47], v[220:223], v[176:179], v[44:47]
    ds_read_b64_tr_b16 v[176:177], v228
    s_waitcnt lgkmcnt(3)
    v_mfma_f32_16x16x32_bf16 v[48:51], v[208:211], v[180:183], v[48:51]
    ds_read_b64_tr_b16 v[178:179], v228 offset:1024
    v_mfma_f32_16x16x32_bf16 v[52:55], v[212:215], v[180:183], v[52:55]
    ds_read_b128 v[200:203], v225
    v_mfma_f32_16x16x32_bf16 v[56:59], v[216:219], v[180:183], v[56:59]
    ds_read_b128 v[204:207], v225 offset:2048
    v_mfma_f32_16x16x32_bf16 v[60:63], v[220:223], v[180:183], v[60:63]
    ds_read_b64_tr_b16 v[180:181], v229
    s_waitcnt lgkmcnt(3)
    v_mfma_f32_16x16x32_bf16 v[32:35], v[192:195], v[176:179], v[32:35]
    ds_read_b64_tr_b16 v[182:183], v229 offset:1024
    v_mfma_f32_16x16x32_bf16 v[36:39], v[196:199], v[176:179], v[36:39]
    ds_read_b128 v[208:211], v226
    s_waitcnt lgkmcnt(4)
    v_mfma_f32_16x16x32_bf16 v[40:43], v[200:203], v[176:179], v[40:43]
    ds_read_b128 v[212:215], v226 offset:2048
    s_waitcnt lgkmcnt(4)
    v_mfma_f32_16x16x32_bf16 v[44:47], v[204:207], v[176:179], v[44:47]
    ds_read_b64_tr_b16 v[176:177], v228 offset:8192
    s_waitcnt lgkmcnt(3)
    v_mfma_f32_16x16x32_bf16 v[48:51], v[192:195], v[180:183], v[48:51]
    ds_read_b64_tr_b16 v[178:179], v228 offset:9216
    v_mfma_f32_16x16x32_bf16 v[52:55], v[196:199], v[180:183], v[52:55]
    ds_read_b128 v[216:219], v227
    v_mfma_f32_16x16x32_bf16 v[56:59], v[200:203], v[180:183], v[56:59]
    ds_read_b128 v[220:223], v227 offset:2048
    v_mfma_f32_16x16x32_bf16 v[60:63], v[204:207], v[180:183], v[60:63]
    ds_read_b64_tr_b16 v[180:181], v229 offset:8192
    s_waitcnt lgkmcnt(3)
    v_mfma_f32_16x16x32_bf16 v[32:35], v[208:211], v[176:179], v[32:35]
    ds_read_b64_tr_b16 v[182:183], v229 offset:9216
    s_barrier
    v_mfma_f32_16x16x32_bf16 v[36:39], v[212:215], v[176:179], v[36:39]
    ds_read_b128 v[192:195], v224 offset:32768
    s_waitcnt lgkmcnt(4)
    v_mfma_f32_16x16x32_bf16 v[40:43], v[216:219], v[176:179], v[40:43]
    ds_read_b128 v[196:199], v224 offset:34816
    v_add_u32 v224, 65536, v224
    s_waitcnt lgkmcnt(4)
    v_mfma_f32_16x16x32_bf16 v[44:47], v[220:223], v[176:179], v[44:47]
    ds_read_b64_tr_b16 v[176:177], v228 offset:32768
    s_waitcnt lgkmcnt(3)
    v_mfma_f32_16x16x32_bf16 v[48:51], v[208:211], v[180:183], v[48:51]
    ds_read_b64_tr_b16 v[178:179], v228 offset:33792
    v_mfma_f32_16x16x32_bf16 v[52:55], v[212:215], v[180:183], v[52:55]
    ds_read_b128 v[200:203], v225 offset:32768
    v_mfma_f32_16x16x32_bf16 v[56:59], v[216:219], v[180:183], v[56:59]
    ds_read_b128 v[204:207], v225 offset:34816
    v_add_u32 v225, 65536, v225
    v_mfma_f32_16x16x32_bf16 v[60:63], v[220:223], v[180:183], v[60:63]
    ds_read_b64_tr_b16 v[180:181], v229 offset:32768
    s_waitcnt lgkmcnt(3)
    v_mfma_f32_16x16x32_bf16 v[0:3], v[192:195], v[176:179], 0
    ds_read_b64_tr_b16 v[182:183], v229 offset:33792
    v_mfma_f32_16x16x32_bf16 v[4:7], v[196:199], v[176:179], 0
    ds_read_b128 v[208:211], v226 offset:32768
    s_waitcnt lgkmcnt(4)
    v_mfma_f32_16x16x32_bf16 v[8:11], v[200:203], v[176:179], 0
    ds_read_b128 v[212:215], v226 offset:34816
    v_add_u32 v226, 65536, v226
    s_waitcnt lgkmcnt(4)
    v_mfma_f32_16x16x32_bf16 v[12:15], v[204:207], v[176:179], 0
    ds_read_b64_tr_b16 v[176:177], v228 offset:40960
    s_waitcnt lgkmcnt(3)
    v_mfma_f32_16x16x32_bf16 v[16:19], v[192:195], v[180:183], 0
    ds_read_b64_tr_b16 v[178:179], v228 offset:41984
    v_add_u32 v228, 65536, v228
    v_mfma_f32_16x16x32_bf16 v[20:23], v[196:199], v[180:183], 0
    ds_read_b128 v[216:219], v227 offset:32768
    v_mfma_f32_16x16x32_bf16 v[24:27], v[200:203], v[180:183], 0
    ds_read_b128 v[220:223], v227 offset:34816
    v_add_u32 v227, 65536, v227
    v_mfma_f32_16x16x32_bf16 v[28:31], v[204:207], v[180:183], 0
    ds_read_b64_tr_b16 v[180:181], v229 offset:40960
    s_waitcnt lgkmcnt(3)
    v_mfma_f32_16x16x32_bf16 v[0:3], v[208:211], v[176:179], v[0:3]
    ds_read_b64_tr_b16 v[182:183], v229 offset:41984
    v_add_u32 v229, 65536, v229
    s_barrier
    v_cvt_pk_bf16_f32 v88, v32, v33
    v_cvt_pk_bf16_f32 v89, v34, v35
    v_mfma_f32_16x16x32_bf16 v[4:7], v[212:215], v[176:179], v[4:7]
    ds_read_b128 v[192:195], v224
    v_cvt_pk_bf16_f32 v90, v36, v37
    v_cvt_pk_bf16_f32 v91, v38, v39
    s_waitcnt lgkmcnt(4)
    v_mfma_f32_16x16x32_bf16 v[8:11], v[216:219], v[176:179], v[8:11]
    ds_read_b128 v[196:199], v224 offset:2048
    v_subrev_u32 v224, 131072, v224
    v_cvt_pk_bf16_f32 v120, v40, v41
    v_cvt_pk_bf16_f32 v121, v42, v43
    s_waitcnt lgkmcnt(4)
    v_mfma_f32_16x16x32_bf16 v[12:15], v[220:223], v[176:179], v[12:15]
    ds_read_b64_tr_b16 v[176:177], v228
    v_cvt_pk_bf16_f32 v122, v44, v45
    v_cvt_pk_bf16_f32 v123, v46, v47
    s_waitcnt lgkmcnt(3)
    v_mfma_f32_16x16x32_bf16 v[16:19], v[208:211], v[180:183], v[16:19]
    ds_read_b64_tr_b16 v[178:179], v228 offset:1024
    v_cvt_pk_bf16_f32 v92, v48, v49
    v_cvt_pk_bf16_f32 v93, v50, v51
    v_mfma_f32_16x16x32_bf16 v[20:23], v[212:215], v[180:183], v[20:23]
    ds_read_b128 v[200:203], v225
    v_cvt_pk_bf16_f32 v94, v52, v53
    v_cvt_pk_bf16_f32 v95, v54, v55
    v_mfma_f32_16x16x32_bf16 v[24:27], v[216:219], v[180:183], v[24:27]
    ds_read_b128 v[204:207], v225 offset:2048
    v_subrev_u32 v225, 131072, v225
    v_cvt_pk_bf16_f32 v124, v56, v57
    v_cvt_pk_bf16_f32 v125, v58, v59
    v_mfma_f32_16x16x32_bf16 v[28:31], v[220:223], v[180:183], v[28:31]
    ds_read_b64_tr_b16 v[180:181], v229
    v_cvt_pk_bf16_f32 v126, v60, v61
    v_cvt_pk_bf16_f32 v127, v62, v63
    s_waitcnt lgkmcnt(3)
    v_mfma_f32_16x16x32_bf16 v[0:3], v[192:195], v[176:179], v[0:3]
    ds_read_b64_tr_b16 v[182:183], v229 offset:1024
    v_mfma_f32_16x16x32_bf16 v[4:7], v[196:199], v[176:179], v[4:7]
    ds_read_b128 v[208:211], v226
    s_waitcnt lgkmcnt(4)
    v_mfma_f32_16x16x32_bf16 v[8:11], v[200:203], v[176:179], v[8:11]
    ds_read_b128 v[212:215], v226 offset:2048
    v_subrev_u32 v226, 131072, v226
    s_waitcnt lgkmcnt(4)
    v_mfma_f32_16x16x32_bf16 v[12:15], v[204:207], v[176:179], v[12:15]
    ds_read_b64_tr_b16 v[176:177], v228 offset:8192
    s_waitcnt lgkmcnt(3)
    v_mfma_f32_16x16x32_bf16 v[16:19], v[192:195], v[180:183], v[16:19]
    ds_read_b64_tr_b16 v[178:179], v228 offset:9216
    v_subrev_u32 v228, 131072, v228
    v_mfma_f32_16x16x32_bf16 v[20:23], v[196:199], v[180:183], v[20:23]
    ds_read_b128 v[216:219], v227
    v_mfma_f32_16x16x32_bf16 v[24:27], v[200:203], v[180:183], v[24:27]
    ds_read_b128 v[220:223], v227 offset:2048
    v_subrev_u32 v227, 131072, v227
    v_mfma_f32_16x16x32_bf16 v[28:31], v[204:207], v[180:183], v[28:31]
    ds_read_b64_tr_b16 v[180:181], v229 offset:8192
    s_waitcnt lgkmcnt(3)
    v_mfma_f32_16x16x32_bf16 v[0:3], v[208:211], v[176:179], v[0:3]
    ds_read_b64_tr_b16 v[182:183], v229 offset:9216
    v_subrev_u32 v229, 131072, v229
    s_barrier
    v_mfma_f32_16x16x32_bf16 v[4:7], v[212:215], v[176:179], v[4:7]
    ds_read_b128 v[192:195], v224
    s_waitcnt lgkmcnt(4)
    v_mfma_f32_16x16x32_bf16 v[8:11], v[216:219], v[176:179], v[8:11]
    ds_read_b128 v[196:199], v224 offset:2048
    s_waitcnt lgkmcnt(4)
    v_mfma_f32_16x16x32_bf16 v[12:15], v[220:223], v[176:179], v[12:15]
    ds_read_b64_tr_b16 v[176:177], v228
    s_waitcnt lgkmcnt(3)
    v_mfma_f32_16x16x32_bf16 v[16:19], v[208:211], v[180:183], v[16:19]
    ds_read_b64_tr_b16 v[178:179], v228 offset:1024
    v_mfma_f32_16x16x32_bf16 v[20:23], v[212:215], v[180:183], v[20:23]
    ds_read_b128 v[200:203], v225
    v_mfma_f32_16x16x32_bf16 v[24:27], v[216:219], v[180:183], v[24:27]
    ds_read_b128 v[204:207], v225 offset:2048
    v_mfma_f32_16x16x32_bf16 v[28:31], v[220:223], v[180:183], v[28:31]
    ds_read_b64_tr_b16 v[180:181], v229
    s_waitcnt lgkmcnt(3)
    v_mfma_f32_16x16x32_bf16 v[0:3], v[192:195], v[176:179], v[0:3]
    ds_read_b64_tr_b16 v[182:183], v229 offset:1024
    v_mfma_f32_16x16x32_bf16 v[4:7], v[196:199], v[176:179], v[4:7]
    ds_read_b128 v[208:211], v226
    s_waitcnt lgkmcnt(4)
    v_mfma_f32_16x16x32_bf16 v[8:11], v[200:203], v[176:179], v[8:11]
    ds_read_b128 v[212:215], v226 offset:2048
    s_waitcnt lgkmcnt(4)
    v_mfma_f32_16x16x32_bf16 v[12:15], v[204:207], v[176:179], v[12:15]
    ds_read_b64_tr_b16 v[176:177], v228 offset:8192
    s_waitcnt lgkmcnt(3)
    v_mfma_f32_16x16x32_bf16 v[16:19], v[192:195], v[180:183], v[16:19]
    ds_read_b64_tr_b16 v[178:179], v228 offset:9216
    v_mfma_f32_16x16x32_bf16 v[20:23], v[196:199], v[180:183], v[20:23]
    ds_read_b128 v[216:219], v227
    v_mfma_f32_16x16x32_bf16 v[24:27], v[200:203], v[180:183], v[24:27]
    ds_read_b128 v[220:223], v227 offset:2048
    v_mfma_f32_16x16x32_bf16 v[28:31], v[204:207], v[180:183], v[28:31]
    ds_read_b64_tr_b16 v[180:181], v229 offset:8192
    s_waitcnt lgkmcnt(3)
    v_mfma_f32_16x16x32_bf16 v[0:3], v[208:211], v[176:179], v[0:3]
    ds_read_b64_tr_b16 v[182:183], v229 offset:9216
    s_barrier
    v_mfma_f32_16x16x32_bf16 v[4:7], v[212:215], v[176:179], v[4:7]
    ds_read_b128 v[192:195], v224 offset:32768
    s_waitcnt lgkmcnt(4)
    v_mfma_f32_16x16x32_bf16 v[8:11], v[216:219], v[176:179], v[8:11]
    ds_read_b128 v[196:199], v224 offset:34816
    v_add_u32 v224, 65536, v224
    s_waitcnt lgkmcnt(4)
    v_mfma_f32_16x16x32_bf16 v[12:15], v[220:223], v[176:179], v[12:15]
    ds_read_b64_tr_b16 v[176:177], v228 offset:32768
    s_waitcnt lgkmcnt(3)
    v_mfma_f32_16x16x32_bf16 v[16:19], v[208:211], v[180:183], v[16:19]
    ds_read_b64_tr_b16 v[178:179], v228 offset:33792
    v_mfma_f32_16x16x32_bf16 v[20:23], v[212:215], v[180:183], v[20:23]
    ds_read_b128 v[200:203], v225 offset:32768
    v_mfma_f32_16x16x32_bf16 v[24:27], v[216:219], v[180:183], v[24:27]
    ds_read_b128 v[204:207], v225 offset:34816
    v_add_u32 v225, 65536, v225
    v_mfma_f32_16x16x32_bf16 v[28:31], v[220:223], v[180:183], v[28:31]
    ds_read_b64_tr_b16 v[180:181], v229 offset:32768
    s_waitcnt lgkmcnt(3)
    v_mfma_f32_16x16x32_bf16 v[0:3], v[192:195], v[176:179], v[0:3]
    ds_read_b64_tr_b16 v[182:183], v229 offset:33792
    v_mfma_f32_16x16x32_bf16 v[4:7], v[196:199], v[176:179], v[4:7]
    ds_read_b128 v[208:211], v226 offset:32768
    s_waitcnt lgkmcnt(4)
    v_mfma_f32_16x16x32_bf16 v[8:11], v[200:203], v[176:179], v[8:11]
    ds_read_b128 v[212:215], v226 offset:34816
    v_add_u32 v226, 65536, v226
    s_waitcnt lgkmcnt(4)
    v_mfma_f32_16x16x32_bf16 v[12:15], v[204:207], v[176:179], v[12:15]
    ds_read_b64_tr_b16 v[176:177], v228 offset:40960
    s_waitcnt lgkmcnt(3)
    v_mfma_f32_16x16x32_bf16 v[16:19], v[192:195], v[180:183], v[16:19]
    ds_read_b64_tr_b16 v[178:179], v228 offset:41984
    v_add_u32 v228, 65536, v228
    v_mfma_f32_16x16x32_bf16 v[20:23], v[196:199], v[180:183], v[20:23]
    ds_read_b128 v[216:219], v227 offset:32768
    v_mfma_f32_16x16x32_bf16 v[24:27], v[200:203], v[180:183], v[24:27]
    ds_read_b128 v[220:223], v227 offset:34816
    v_add_u32 v227, 65536, v227
    v_mfma_f32_16x16x32_bf16 v[28:31], v[204:207], v[180:183], v[28:31]
    ds_read_b64_tr_b16 v[180:181], v229 offset:40960
    s_waitcnt lgkmcnt(3)
    v_mfma_f32_16x16x32_bf16 v[0:3], v[208:211], v[176:179], v[0:3]
    ds_read_b64_tr_b16 v[182:183], v229 offset:41984
    v_add_u32 v229, 65536, v229
    s_barrier
    v_mfma_f32_16x16x32_bf16 v[4:7], v[212:215], v[176:179], v[4:7]
    ds_read_b128 v[192:195], v224
    s_waitcnt lgkmcnt(4)
    v_mfma_f32_16x16x32_bf16 v[8:11], v[216:219], v[176:179], v[8:11]
    ds_read_b128 v[196:199], v224 offset:2048
    s_waitcnt lgkmcnt(4)
    v_mfma_f32_16x16x32_bf16 v[12:15], v[220:223], v[176:179], v[12:15]
    ds_read_b64_tr_b16 v[176:177], v228
    s_waitcnt lgkmcnt(3)
    v_mfma_f32_16x16x32_bf16 v[16:19], v[208:211], v[180:183], v[16:19]
    ds_read_b64_tr_b16 v[178:179], v228 offset:1024
    v_mfma_f32_16x16x32_bf16 v[20:23], v[212:215], v[180:183], v[20:23]
    ds_read_b128 v[200:203], v225
    v_mfma_f32_16x16x32_bf16 v[24:27], v[216:219], v[180:183], v[24:27]
    ds_read_b128 v[204:207], v225 offset:2048
    v_mfma_f32_16x16x32_bf16 v[28:31], v[220:223], v[180:183], v[28:31]
    ds_read_b64_tr_b16 v[180:181], v229
    s_waitcnt lgkmcnt(3)
    v_mfma_f32_16x16x32_bf16 v[32:35], v[192:195], v[176:179], 0
    ds_read_b64_tr_b16 v[182:183], v229 offset:1024
    v_mfma_f32_16x16x32_bf16 v[36:39], v[196:199], v[176:179], 0
    ds_read_b128 v[208:211], v226
    s_waitcnt lgkmcnt(4)
    v_mfma_f32_16x16x32_bf16 v[40:43], v[200:203], v[176:179], 0
    ds_read_b128 v[212:215], v226 offset:2048
    s_waitcnt lgkmcnt(4)
    v_mfma_f32_16x16x32_bf16 v[44:47], v[204:207], v[176:179], 0
    ds_read_b64_tr_b16 v[176:177], v228 offset:8192
    s_waitcnt lgkmcnt(3)
    v_mfma_f32_16x16x32_bf16 v[48:51], v[192:195], v[180:183], 0
    ds_read_b64_tr_b16 v[178:179], v228 offset:9216
    v_mfma_f32_16x16x32_bf16 v[52:55], v[196:199], v[180:183], 0
    ds_read_b128 v[216:219], v227
    v_mfma_f32_16x16x32_bf16 v[56:59], v[200:203], v[180:183], 0
    ds_read_b128 v[220:223], v227 offset:2048
    v_mfma_f32_16x16x32_bf16 v[60:63], v[204:207], v[180:183], 0
    ds_read_b64_tr_b16 v[180:181], v229 offset:8192
    s_waitcnt lgkmcnt(3)
    v_mfma_f32_16x16x32_bf16 v[32:35], v[208:211], v[176:179], v[32:35]
    ds_read_b64_tr_b16 v[182:183], v229 offset:9216
    s_barrier
    v_cvt_pk_bf16_f32 v96, v0, v1
    v_cvt_pk_bf16_f32 v97, v2, v3
    v_mfma_f32_16x16x32_bf16 v[36:39], v[212:215], v[176:179], v[36:39]
    ds_read_b128 v[192:195], v224 offset:32768
    v_cvt_pk_bf16_f32 v98, v4, v5
    v_cvt_pk_bf16_f32 v99, v6, v7
    s_waitcnt lgkmcnt(4)
    v_mfma_f32_16x16x32_bf16 v[40:43], v[216:219], v[176:179], v[40:43]
    ds_read_b128 v[196:199], v224 offset:34816
    v_add_u32 v224, 65536, v224
    v_cvt_pk_bf16_f32 v128, v8, v9
    v_cvt_pk_bf16_f32 v129, v10, v11
    s_waitcnt lgkmcnt(4)
    v_mfma_f32_16x16x32_bf16 v[44:47], v[220:223], v[176:179], v[44:47]
    ds_read_b64_tr_b16 v[176:177], v228 offset:32768
    v_cvt_pk_bf16_f32 v130, v12, v13
    v_cvt_pk_bf16_f32 v131, v14, v15
    s_waitcnt lgkmcnt(3)
    v_mfma_f32_16x16x32_bf16 v[48:51], v[208:211], v[180:183], v[48:51]
    ds_read_b64_tr_b16 v[178:179], v228 offset:33792
    v_cvt_pk_bf16_f32 v100, v16, v17
    v_cvt_pk_bf16_f32 v101, v18, v19
    v_mfma_f32_16x16x32_bf16 v[52:55], v[212:215], v[180:183], v[52:55]
    ds_read_b128 v[200:203], v225 offset:32768
    v_cvt_pk_bf16_f32 v102, v20, v21
    v_cvt_pk_bf16_f32 v103, v22, v23
    v_mfma_f32_16x16x32_bf16 v[56:59], v[216:219], v[180:183], v[56:59]
    ds_read_b128 v[204:207], v225 offset:34816
    v_add_u32 v225, 65536, v225
    v_cvt_pk_bf16_f32 v132, v24, v25
    v_cvt_pk_bf16_f32 v133, v26, v27
    v_mfma_f32_16x16x32_bf16 v[60:63], v[220:223], v[180:183], v[60:63]
    ds_read_b64_tr_b16 v[180:181], v229 offset:32768
    v_cvt_pk_bf16_f32 v134, v28, v29
    v_cvt_pk_bf16_f32 v135, v30, v31
    s_waitcnt lgkmcnt(3)
    v_mfma_f32_16x16x32_bf16 v[32:35], v[192:195], v[176:179], v[32:35]
    ds_read_b64_tr_b16 v[182:183], v229 offset:33792
    v_mfma_f32_16x16x32_bf16 v[36:39], v[196:199], v[176:179], v[36:39]
    ds_read_b128 v[208:211], v226 offset:32768
    s_waitcnt lgkmcnt(4)
    v_mfma_f32_16x16x32_bf16 v[40:43], v[200:203], v[176:179], v[40:43]
    ds_read_b128 v[212:215], v226 offset:34816
    v_add_u32 v226, 65536, v226
    s_waitcnt lgkmcnt(4)
    v_mfma_f32_16x16x32_bf16 v[44:47], v[204:207], v[176:179], v[44:47]
    ds_read_b64_tr_b16 v[176:177], v228 offset:40960
    s_waitcnt lgkmcnt(3)
    v_mfma_f32_16x16x32_bf16 v[48:51], v[192:195], v[180:183], v[48:51]
    ds_read_b64_tr_b16 v[178:179], v228 offset:41984
    v_add_u32 v228, 65536, v228
    v_mfma_f32_16x16x32_bf16 v[52:55], v[196:199], v[180:183], v[52:55]
    ds_read_b128 v[216:219], v227 offset:32768
    v_mfma_f32_16x16x32_bf16 v[56:59], v[200:203], v[180:183], v[56:59]
    ds_read_b128 v[220:223], v227 offset:34816
    v_add_u32 v227, 65536, v227
    v_mfma_f32_16x16x32_bf16 v[60:63], v[204:207], v[180:183], v[60:63]
    ds_read_b64_tr_b16 v[180:181], v229 offset:40960
    s_waitcnt lgkmcnt(3)
    v_mfma_f32_16x16x32_bf16 v[32:35], v[208:211], v[176:179], v[32:35]
    ds_read_b64_tr_b16 v[182:183], v229 offset:41984
    v_add_u32 v229, 65536, v229
    s_barrier
    v_mfma_f32_16x16x32_bf16 v[36:39], v[212:215], v[176:179], v[36:39]
    ds_read_b128 v[192:195], v224
    s_waitcnt lgkmcnt(4)
    v_mfma_f32_16x16x32_bf16 v[40:43], v[216:219], v[176:179], v[40:43]
    ds_read_b128 v[196:199], v224 offset:2048
    v_subrev_u32 v224, 131072, v224
    s_waitcnt lgkmcnt(4)
    v_mfma_f32_16x16x32_bf16 v[44:47], v[220:223], v[176:179], v[44:47]
    ds_read_b64_tr_b16 v[176:177], v228
    s_waitcnt lgkmcnt(3)
    v_mfma_f32_16x16x32_bf16 v[48:51], v[208:211], v[180:183], v[48:51]
    ds_read_b64_tr_b16 v[178:179], v228 offset:1024
    v_mfma_f32_16x16x32_bf16 v[52:55], v[212:215], v[180:183], v[52:55]
    ds_read_b128 v[200:203], v225
    v_mfma_f32_16x16x32_bf16 v[56:59], v[216:219], v[180:183], v[56:59]
    ds_read_b128 v[204:207], v225 offset:2048
    v_subrev_u32 v225, 131072, v225
    v_mfma_f32_16x16x32_bf16 v[60:63], v[220:223], v[180:183], v[60:63]
    ds_read_b64_tr_b16 v[180:181], v229
    s_waitcnt lgkmcnt(3)
    v_mfma_f32_16x16x32_bf16 v[32:35], v[192:195], v[176:179], v[32:35]
    ds_read_b64_tr_b16 v[182:183], v229 offset:1024
    v_mfma_f32_16x16x32_bf16 v[36:39], v[196:199], v[176:179], v[36:39]
    ds_read_b128 v[208:211], v226
    s_waitcnt lgkmcnt(4)
    v_mfma_f32_16x16x32_bf16 v[40:43], v[200:203], v[176:179], v[40:43]
    ds_read_b128 v[212:215], v226 offset:2048
    v_subrev_u32 v226, 131072, v226
    s_waitcnt lgkmcnt(4)
    v_mfma_f32_16x16x32_bf16 v[44:47], v[204:207], v[176:179], v[44:47]
    ds_read_b64_tr_b16 v[176:177], v228 offset:8192
    s_waitcnt lgkmcnt(3)
    v_mfma_f32_16x16x32_bf16 v[48:51], v[192:195], v[180:183], v[48:51]
    ds_read_b64_tr_b16 v[178:179], v228 offset:9216
    v_subrev_u32 v228, 131072, v228
    v_mfma_f32_16x16x32_bf16 v[52:55], v[196:199], v[180:183], v[52:55]
    ds_read_b128 v[216:219], v227
    v_mfma_f32_16x16x32_bf16 v[56:59], v[200:203], v[180:183], v[56:59]
    ds_read_b128 v[220:223], v227 offset:2048
    v_subrev_u32 v227, 131072, v227
    v_mfma_f32_16x16x32_bf16 v[60:63], v[204:207], v[180:183], v[60:63]
    ds_read_b64_tr_b16 v[180:181], v229 offset:8192
    s_waitcnt lgkmcnt(3)
    v_mfma_f32_16x16x32_bf16 v[32:35], v[208:211], v[176:179], v[32:35]
    ds_read_b64_tr_b16 v[182:183], v229 offset:9216
    v_subrev_u32 v229, 131072, v229
    s_barrier
    v_mfma_f32_16x16x32_bf16 v[36:39], v[212:215], v[176:179], v[36:39]
    ds_read_b128 v[192:195], v224
    s_waitcnt lgkmcnt(4)
    v_mfma_f32_16x16x32_bf16 v[40:43], v[216:219], v[176:179], v[40:43]
    ds_read_b128 v[196:199], v224 offset:2048
    s_waitcnt lgkmcnt(4)
    v_mfma_f32_16x16x32_bf16 v[44:47], v[220:223], v[176:179], v[44:47]
    ds_read_b64_tr_b16 v[176:177], v228
    s_waitcnt lgkmcnt(3)
    v_mfma_f32_16x16x32_bf16 v[48:51], v[208:211], v[180:183], v[48:51]
    ds_read_b64_tr_b16 v[178:179], v228 offset:1024
    v_mfma_f32_16x16x32_bf16 v[52:55], v[212:215], v[180:183], v[52:55]
    ds_read_b128 v[200:203], v225
    v_mfma_f32_16x16x32_bf16 v[56:59], v[216:219], v[180:183], v[56:59]
    ds_read_b128 v[204:207], v225 offset:2048
    v_mfma_f32_16x16x32_bf16 v[60:63], v[220:223], v[180:183], v[60:63]
    ds_read_b64_tr_b16 v[180:181], v229
    s_waitcnt lgkmcnt(3)
    v_mfma_f32_16x16x32_bf16 v[32:35], v[192:195], v[176:179], v[32:35]
    ds_read_b64_tr_b16 v[182:183], v229 offset:1024
    v_mfma_f32_16x16x32_bf16 v[36:39], v[196:199], v[176:179], v[36:39]
    ds_read_b128 v[208:211], v226
    s_waitcnt lgkmcnt(4)
    v_mfma_f32_16x16x32_bf16 v[40:43], v[200:203], v[176:179], v[40:43]
    ds_read_b128 v[212:215], v226 offset:2048
    s_waitcnt lgkmcnt(4)
    v_mfma_f32_16x16x32_bf16 v[44:47], v[204:207], v[176:179], v[44:47]
    ds_read_b64_tr_b16 v[176:177], v228 offset:8192
    s_waitcnt lgkmcnt(3)
    v_mfma_f32_16x16x32_bf16 v[48:51], v[192:195], v[180:183], v[48:51]
    ds_read_b64_tr_b16 v[178:179], v228 offset:9216
    v_mfma_f32_16x16x32_bf16 v[52:55], v[196:199], v[180:183], v[52:55]
    ds_read_b128 v[216:219], v227
    v_mfma_f32_16x16x32_bf16 v[56:59], v[200:203], v[180:183], v[56:59]
    ds_read_b128 v[220:223], v227 offset:2048
    v_mfma_f32_16x16x32_bf16 v[60:63], v[204:207], v[180:183], v[60:63]
    ds_read_b64_tr_b16 v[180:181], v229 offset:8192
    s_waitcnt lgkmcnt(3)
    v_mfma_f32_16x16x32_bf16 v[32:35], v[208:211], v[176:179], v[32:35]
    ds_read_b64_tr_b16 v[182:183], v229 offset:9216
    v_mfma_f32_16x16x32_bf16 v[36:39], v[212:215], v[176:179], v[36:39]
    s_waitcnt lgkmcnt(3)
    v_mfma_f32_16x16x32_bf16 v[40:43], v[216:219], v[176:179], v[40:43]
    s_waitcnt lgkmcnt(2)
    v_mfma_f32_16x16x32_bf16 v[44:47], v[220:223], v[176:179], v[44:47]
    s_waitcnt lgkmcnt(0)
    v_mfma_f32_16x16x32_bf16 v[48:51], v[208:211], v[180:183], v[48:51]
    v_mfma_f32_16x16x32_bf16 v[52:55], v[212:215], v[180:183], v[52:55]
    v_mfma_f32_16x16x32_bf16 v[56:59], v[216:219], v[180:183], v[56:59]
    v_mfma_f32_16x16x32_bf16 v[60:63], v[220:223], v[180:183], v[60:63]
    v_cvt_pk_bf16_f32 v104, v32, v33
    v_cvt_pk_bf16_f32 v105, v34, v35
    v_cvt_pk_bf16_f32 v106, v36, v37
    v_cvt_pk_bf16_f32 v107, v38, v39
    v_cvt_pk_bf16_f32 v136, v40, v41
    v_cvt_pk_bf16_f32 v137, v42, v43
    v_cvt_pk_bf16_f32 v138, v44, v45
    v_cvt_pk_bf16_f32 v139, v46, v47
    v_cvt_pk_bf16_f32 v108, v48, v49
    v_cvt_pk_bf16_f32 v109, v50, v51
    v_cvt_pk_bf16_f32 v110, v52, v53
    v_cvt_pk_bf16_f32 v111, v54, v55
    v_cvt_pk_bf16_f32 v140, v56, v57
    v_cvt_pk_bf16_f32 v141, v58, v59
    v_cvt_pk_bf16_f32 v142, v60, v61
    v_cvt_pk_bf16_f32 v143, v62, v63
    s_barrier
    ds_read_b128 v[192:195], v232
    ds_read_b128 v[196:199], v232 offset:1024
    ds_read_b128 v[200:203], v232 offset:2048
    ds_read_b128 v[204:207], v232 offset:3072
    ds_read_b128 v[208:211], v232 offset:4096
    ds_read_b128 v[212:215], v232 offset:5120
    ds_read_b128 v[216:219], v232 offset:6144
    ds_read_b128 v[220:223], v232 offset:7168
    s_waitcnt lgkmcnt(7)
    v_mfma_f32_16x16x32_bf16 v[0:3], v[80:83], v[192:195], 0
    v_mfma_f32_16x16x32_bf16 v[4:7], v[84:87], v[192:195], 0
    ds_read_b128 v[192:195], v233
    s_waitcnt lgkmcnt(7)
    v_mfma_f32_16x16x32_bf16 v[8:11], v[80:83], v[196:199], 0
    v_mfma_f32_16x16x32_bf16 v[12:15], v[84:87], v[196:199], 0
    ds_read_b128 v[196:199], v233 offset:1024
    s_waitcnt lgkmcnt(7)
    v_mfma_f32_16x16x32_bf16 v[0:3], v[88:91], v[200:203], v[0:3]
    v_mfma_f32_16x16x32_bf16 v[4:7], v[92:95], v[200:203], v[4:7]
    ds_read_b128 v[200:203], v233 offset:2048
    s_waitcnt lgkmcnt(7)
    v_mfma_f32_16x16x32_bf16 v[8:11], v[88:91], v[204:207], v[8:11]
    v_mfma_f32_16x16x32_bf16 v[12:15], v[92:95], v[204:207], v[12:15]
    ds_read_b128 v[204:207], v233 offset:3072
    s_waitcnt lgkmcnt(7)
    v_mfma_f32_16x16x32_bf16 v[0:3], v[96:99], v[208:211], v[0:3]
    v_mfma_f32_16x16x32_bf16 v[4:7], v[100:103], v[208:211], v[4:7]
    ds_read_b128 v[208:211], v233 offset:4096
    s_waitcnt lgkmcnt(5)
    v_mfma_f32_16x16x32_bf16 v[8:11], v[96:99], v[212:215], v[8:11]
    v_mfma_f32_16x16x32_bf16 v[12:15], v[100:103], v[212:215], v[12:15]
    ds_read_b128 v[212:215], v233 offset:5120
    v_mfma_f32_16x16x32_bf16 v[0:3], v[104:107], v[216:219], v[0:3]
    v_mfma_f32_16x16x32_bf16 v[4:7], v[108:111], v[216:219], v[4:7]
    ds_read_b128 v[216:219], v233 offset:6144
    v_mfma_f32_16x16x32_bf16 v[8:11], v[104:107], v[220:223], v[8:11]
    v_mfma_f32_16x16x32_bf16 v[12:15], v[108:111], v[220:223], v[12:15]
    ds_read_b128 v[220:223], v233 offset:7168
    s_waitcnt lgkmcnt(6)
    v_mfma_f32_16x16x32_bf16 v[16:19], v[112:115], v[192:195], 0
    v_mfma_f32_16x16x32_bf16 v[20:23], v[116:119], v[192:195], 0
    v_mfma_f32_16x16x32_bf16 v[24:27], v[112:115], v[196:199], 0
    v_cvt_pk_bf16_f32 v0, v0, v1
    v_cvt_pk_bf16_f32 v1, v2, v3
    v_cvt_pk_bf16_f32 v2, v4, v5
    v_cvt_pk_bf16_f32 v3, v6, v7
    buffer_store_dwordx4 v[0:3], v238, s[44:47], s28 offen offset:0 sc1
    buffer_store_dword v241, v237, s[44:47], s63 offen sc1
    v_mfma_f32_16x16x32_bf16 v[28:31], v[116:119], v[196:199], 0
    s_waitcnt lgkmcnt(3)
    v_mfma_f32_16x16x32_bf16 v[16:19], v[120:123], v[200:203], v[16:19]
    v_mfma_f32_16x16x32_bf16 v[20:23], v[124:127], v[200:203], v[20:23]
    v_mfma_f32_16x16x32_bf16 v[24:27], v[120:123], v[204:207], v[24:27]
    v_cvt_pk_bf16_f32 v4, v8, v9
    v_cvt_pk_bf16_f32 v5, v10, v11
    v_cvt_pk_bf16_f32 v6, v12, v13
    v_cvt_pk_bf16_f32 v7, v14, v15
    buffer_store_dwordx4 v[4:7], v238, s[44:47], s28 offen offset:1024 sc1
    v_mfma_f32_16x16x32_bf16 v[28:31], v[124:127], v[204:207], v[28:31]
    v_mfma_f32_16x16x32_bf16 v[16:19], v[128:131], v[208:211], v[16:19]
    v_bitop3_b32 v8, v0, v1, v2 bitop3:0x96
    v_bitop3_b32 v9, v3, v4, v5 bitop3:0x96
    v_bitop3_b32 v10, v6, v7, v241 bitop3:0x96
    v_bitop3_b32 v8, v8, v9, v10 bitop3:0x96
    buffer_store_dword v8, v242, s[44:47], s28 offen offset:2048 sc1
    v_mfma_f32_16x16x32_bf16 v[20:23], v[132:135], v[208:211], v[20:23]
    s_waitcnt lgkmcnt(0)
    v_mfma_f32_16x16x32_bf16 v[24:27], v[128:131], v[212:215], v[24:27]
    v_mfma_f32_16x16x32_bf16 v[28:31], v[132:135], v[212:215], v[28:31]
    v_mfma_f32_16x16x32_bf16 v[16:19], v[136:139], v[216:219], v[16:19]
    v_mfma_f32_16x16x32_bf16 v[20:23], v[140:143], v[216:219], v[20:23]
    v_mfma_f32_16x16x32_bf16 v[24:27], v[136:139], v[220:223], v[24:27]
    v_mfma_f32_16x16x32_bf16 v[28:31], v[140:143], v[220:223], v[28:31]
    s_lshr_b32 s56, s23, 1
    s_xor_b32 s56, s56, s26
    s_and_b32 s56, s56, 1
    s_cbranch_scc0 L_U3own
    s_nop 0
    v_cvt_pk_bf16_f32 v16, v16, v17
    v_cvt_pk_bf16_f32 v17, v18, v19
    v_cvt_pk_bf16_f32 v18, v20, v21
    v_cvt_pk_bf16_f32 v19, v22, v23
    buffer_store_dwordx4 v[16:19], v238, s[44:47], s30 offen offset:0 sc1
    buffer_store_dword v241, v237, s[44:47], s64 offen sc1
    v_cvt_pk_bf16_f32 v20, v24, v25
    v_cvt_pk_bf16_f32 v21, v26, v27
    v_cvt_pk_bf16_f32 v22, v28, v29
    v_cvt_pk_bf16_f32 v23, v30, v31
    buffer_store_dwordx4 v[20:23], v238, s[44:47], s30 offen offset:1024 sc1
    v_bitop3_b32 v24, v16, v17, v18 bitop3:0x96
    v_bitop3_b32 v25, v19, v20, v21 bitop3:0x96
    v_bitop3_b32 v26, v22, v23, v241 bitop3:0x96
    v_bitop3_b32 v24, v24, v25, v26 bitop3:0x96
    buffer_store_dword v24, v242, s[44:47], s30 offen offset:2048 sc1
    s_endpgm
L_U3own:
    s_nop 0
    ds_write_b128 v240, v[16:19]
    ds_write_b128 v240, v[20:23] offset:1024
    ds_write_b128 v240, v[24:27] offset:2048
    ds_write_b128 v240, v[28:31] offset:3072
    s_waitcnt lgkmcnt(0)
    s_barrier
L_end:
    s_endpgm
.section .rodata,"a"
.p2align 6
.amdhsa_kernel standalone__mha_block_cached__near_ridge_kernel
  .amdhsa_next_free_vgpr 256
  .amdhsa_next_free_sgpr 72
  .amdhsa_accum_offset 256
  .amdhsa_group_segment_fixed_size 0
  .amdhsa_kernarg_size 64
  .amdhsa_user_sgpr_count 2
  .amdhsa_user_sgpr_kernarg_segment_ptr 1
  .amdhsa_system_sgpr_workgroup_id_x 1
.end_amdhsa_kernel
```
